```python
import torch

def _softmax(x, axis=-1):
    return torch.softmax(x, dim=axis)
def _gelu(x):
    return torch.nn.functional.gelu(x, approximate="tanh")
def _silu(x):
    return torch.nn.functional.silu(x)
def _sigmoid(x):
    return torch.sigmoid(x)
def _layernorm(x, axis=-1, eps=1e-5):
    m = x.mean(dim=axis, keepdim=True)
    v = x.var(dim=axis, keepdim=True, unbiased=False)
    return (x - m) / torch.sqrt(v + eps)
def _scatter_add(tgt, idx, src, axis=0):
    return tgt.clone().index_add_(axis, idx, src)
def _segment_sum(src, seg, n):
    out = torch.zeros((n,) + src.shape[1:], dtype=src.dtype)
    return out.index_add_(0, seg, src)
def _pad(x, pw):
    flat = tuple(v for pair in reversed(pw) for v in pair)
    return torch.nn.functional.pad(x, flat)

kernel_name = 'interleave_layers__ssm_conv_h3__dense_activation_mish__prompt'

def setup_inputs():

    _w = (lambda a: (lambda t: t.to(torch.bfloat16) if t.is_floating_point() else t)(torch.as_tensor(a)))
    def _A_setup():
        B, S, D = 1, 2048, 640
        ks = 4
        return {
            "q": _w((lambda *s: torch.randn(*s, dtype=torch.bfloat16) * 0.05)(B, S, D)),
            "k": _w((lambda *s: torch.randn(*s, dtype=torch.bfloat16) * 0.2)(B, S, D)),
            "v": _w((lambda *s: torch.randn(*s, dtype=torch.bfloat16) * 0.2)(B, S, D)),
            "shift_k": _w((lambda *s: torch.randn(*s, dtype=torch.bfloat16) * 0.2)(D, ks) * 0.5),
            "ssm_k": _w((lambda *s: torch.randn(*s, dtype=torch.bfloat16) * 0.4)(D, S) * (1.0 / S ** 0.5)),
            "ssm_D": _w((lambda *s: torch.randn(*s, dtype=torch.bfloat16) * 0.2)(D)),
        }
    _A_in = _A_setup()

    def _B_setup():
        B, S, D, F = 1, 2048, 640, 1728
        return {
            "x": _w((lambda *s: torch.randn(*s, dtype=torch.bfloat16) * 0.05)(B, S, D)),
            "w1": _w((lambda *s: torch.randn(*s, dtype=torch.bfloat16) * 0.8)(D, F) * (D ** -0.5)),
            "b1": _w((lambda *s: torch.randn(*s, dtype=torch.bfloat16) * 0.2)(F)),
            "w2": _w((lambda *s: torch.randn(*s, dtype=torch.bfloat16) * 0.1)(F, D) * (F ** -0.5)),
        }
    _B_in = _B_setup()

    return {
        "A_q": _A_in["q"],
        "A_k": _A_in["k"],
        "A_v": _A_in["v"],
        "A_shift_k": _A_in["shift_k"],
        "A_ssm_k": _A_in["ssm_k"],
        "A_ssm_D": _A_in["ssm_D"],
        "B_x": _B_in["x"],
        "B_w1": _B_in["w1"],
        "B_b1": _B_in["b1"],
        "B_w2": _B_in["w2"],
    }

def reference(A_q, A_k, A_v, A_shift_k, A_ssm_k, A_ssm_D, B_x, B_w1, B_b1, B_w2):
    def _A_ref(q, k, v, shift_k, ssm_k, ssm_D):
        B, S, D = q.shape
        ks = shift_k.shape[-1]
        k_pad = _pad(k, ((0, 0), (ks - 1, 0), (0, 0)))
        k_shift = torch.zeros_like(k)
        for t in range(ks):
            k_shift = k_shift + k_pad[:, t:t + S, :] * shift_k[:, ks - 1 - t][None, None, :]
        kv = k_shift * v
        L = 2 * S
        kv_pad = _pad(kv, ((0, 0), (0, S), (0, 0)))
        kf_pad = _pad(ssm_k, ((0, 0), (0, S)))
        kv_f = (lambda x, axes=(-2,-1): torch.fft.rfft2(x.float(), dim=axes))(kv_pad[:, None, :, :], axes=(1, 2))
        kf_f = (lambda x, axes=(-2,-1): torch.fft.rfft2(x.float(), dim=axes))(kf_pad[:, None, :], axes=(1, 2))
        kf_f = (lambda x, *d: x.permute(*d))(kf_f, 1, 2, 0)
        y_f = kv_f * kf_f[None, :, :, :]
        y = (lambda x, s, axes=(-2,-1): torch.fft.irfft2(x, s=s, dim=axes).to(torch.bfloat16))(y_f, (1, L), axes=(1, 2))[:, 0, :S, :]
        y = y + kv * ssm_D[None, None, :]
        return q * y

    def _B_ref(x, w1, b1, w2):
        h = torch.einsum("bsd,df->bsf", x, w1) + b1
        sp = torch.log1p(torch.exp(-torch.abs(h))) + torch.where(h > 0, h, torch.zeros_like(h))
        act = h * torch.tanh(sp)
        return torch.einsum("bsf,fd->bsd", act, w2)

    x = A_q
    x = x + _A_ref(_layernorm(x, axis=-1), A_k, A_v, A_shift_k, A_ssm_k, A_ssm_D)
    x = x + _B_ref(_layernorm(x, axis=-1), B_w1, B_b1, B_w2)
    x = x + _A_ref(_layernorm(x, axis=-1), A_k, A_v, A_shift_k, A_ssm_k, A_ssm_D)
    x = x + _B_ref(_layernorm(x, axis=-1), B_w1, B_b1, B_w2)
    return x
```

```asm
; @launch grid=(256,1,1) block=(256,1,1) lds=163840
.amdgcn_target "amdgcn-amd-amdhsa--gfx950"
.text
.globl interleave_layers__ssm_conv_h3__dense_activation_mish__prompt_kernel
.p2align 8
.type interleave_layers__ssm_conv_h3__dense_activation_mish__prompt_kernel,@function
interleave_layers__ssm_conv_h3__dense_activation_mish__prompt_kernel:
    s_cmp_ge_u32 s2, 256
    s_cbranch_scc1 L_end
    s_getpc_b64 s[76:77]
L_pc:
    s_mov_b32 s78, L_codeend-L_pc
    s_mov_b32 s79, 0x20000
    v_lshlrev_b32 v3, 7, v0
    buffer_load_dword v11, v3, s[76:79], 0 offen
    s_load_dwordx2 s[48:49], s[0:1], 8
    s_load_dwordx2 s[52:53], s[0:1], 16
    s_load_dwordx2 s[64:65], s[0:1], 56
    s_load_dwordx2 s[68:69], s[0:1], 72
    s_load_dwordx2 s[56:57], s[0:1], 24
    s_load_dwordx2 s[60:61], s[0:1], 32
    s_load_dwordx2 s[32:33], s[0:1], 96
    s_load_dwordx2 s[44:45], s[0:1], 0
    s_load_dwordx2 s[40:41], s[0:1], 64
    s_load_dwordx2 s[36:37], s[0:1], 80
    s_load_dwordx2 s[30:31], s[0:1], 40
    v_lshrrev_b32 v3, 6, v0
    v_and_b32 v1, 63, v0
    v_lshlrev_b32 v2, 4, v1
    v_readfirstlane_b32 s5, v3
    v_mov_b32 v125, 0x40000000
    v_mov_b32 v4, 160000
    v_mov_b32 v5, 0
    ds_write_b32 v4, v5
    s_sub_u32 s80, s2, 64
    s_cmp_eq_u32 s5, 0
    s_cbranch_scc1 L_r0
    s_mul_i32 s82, s2, 2
    s_sub_u32 s82, s82, 288
    s_cmp_eq_u32 s5, 2
    s_cbranch_scc1 L_r2
    s_cmp_lt_u32 s80, 160
    s_cselect_b32 s81, 1, 3
    s_lshl_b32 s80, s80, 1
    s_cmp_eq_u32 s5, 3
    s_cbranch_scc1 L_r3
    s_mov_b32 s92, 131072
    s_add_u32 s93, s2, 256
    s_cmp_lt_u32 s2, 64
    s_cselect_b32 s95, 0, s81
    s_cselect_b32 s93, s93, s80
    s_branch L_rd
L_r2:
    s_mov_b32 s92, 139264
    s_cmp_lt_u32 s2, 64
    s_cselect_b32 s95, 3, 2
    s_cmp_lt_u32 s2, 224
    s_cselect_b32 s93, s80, s82
    s_branch L_rd
L_r3:
    s_mov_b32 s92, 149504
    s_cmp_lt_u32 s2, 224
    s_cselect_b32 s95, s81, 2
    s_cselect_b32 s93, s80, s82
    s_add_u32 s93, s93, 1
    s_branch L_rd
L_r0:
    s_mov_b32 s92, 122880
    s_mov_b32 s95, 0
    s_mov_b32 s93, s2
L_rd:
    v_mov_b32 v101, v125
    v_mov_b32 v102, v125
    v_mov_b32 v103, v125
    v_mov_b32 v104, v125
    v_mov_b32 v105, v125
    v_mov_b32 v106, v125
    v_mov_b32 v107, v125
    s_cmp_eq_u32 s95, 1
    s_cbranch_scc1 L_i_w1
    s_cmp_eq_u32 s95, 2
    s_cbranch_scc1 L_i_w2
    s_cmp_eq_u32 s95, 3
    s_cbranch_scc1 L_i_no
    s_mov_b32 s50, 2621440
    s_mov_b32 s51, 0x20000
    s_mov_b32 s54, 2621440
    s_mov_b32 s55, 0x20000
    s_mov_b32 s58, 5120
    s_mov_b32 s59, 0x20000
    s_mul_i32 s82, s93, 6554
    s_lshr_b32 s82, s82, 16
    s_mul_i32 s83, s82, 10
    s_sub_u32 s83, s93, s83
    v_and_b32 v23, 7, v1
    v_lshrrev_b32 v24, 3, v1
    s_lshl_b32 s80, s82, 6
    v_lshl_add_u32 v16, v24, 3, s80
    v_mul_u32_u24 v16, 1280, v16
    s_lshl_b32 s80, s83, 7
    v_lshl_add_u32 v16, v23, 4, v16
    v_add_u32 v16, s80, v16
    v_subrev_u32 v17, 3840, v16
    v_add_u32 v19, 5120, v16
    s_lshl_b32 s80, s83, 9
    v_lshl_add_u32 v18, v23, 6, s80
    s_waitcnt lgkmcnt(0)
    s_barrier
    buffer_load_dwordx4 v[56:59], v17, s[48:51], 0 offen offset:0 nt
    buffer_load_dwordx4 v[60:63], v17, s[48:51], 0 offen offset:1280 nt
    buffer_load_dwordx4 v[64:67], v17, s[48:51], 0 offen offset:2560 nt
    buffer_load_dwordx4 v[68:71], v16, s[48:51], 0 offen offset:0 nt
    buffer_load_dwordx4 v[72:75], v16, s[48:51], 0 offen offset:1280 nt
    buffer_load_dwordx4 v[76:79], v16, s[48:51], 0 offen offset:2560 nt
    buffer_load_dwordx4 v[80:83], v16, s[48:51], 0 offen offset:3840 nt
    buffer_load_dwordx4 v[84:87], v19, s[48:51], 0 offen offset:0 nt
    buffer_load_dwordx4 v[88:91], v19, s[48:51], 0 offen offset:1280 nt
    buffer_load_dwordx4 v[92:95], v19, s[48:51], 0 offen offset:2560 nt
    buffer_load_dwordx4 v[96:99], v19, s[48:51], 0 offen offset:3840 nt
    buffer_load_dwordx4 v[128:131], v16, s[52:55], 0 offen offset:0 nt
    buffer_load_dwordx4 v[132:135], v16, s[52:55], 0 offen offset:1280 nt
    buffer_load_dwordx4 v[136:139], v16, s[52:55], 0 offen offset:2560 nt
    buffer_load_dwordx4 v[140:143], v16, s[52:55], 0 offen offset:3840 nt
    buffer_load_dwordx4 v[144:147], v19, s[52:55], 0 offen offset:0 nt
    buffer_load_dwordx4 v[148:151], v19, s[52:55], 0 offen offset:1280 nt
    buffer_load_dwordx4 v[152:155], v19, s[52:55], 0 offen offset:2560 nt
    buffer_load_dwordx4 v[156:159], v19, s[52:55], 0 offen offset:3840 nt
    buffer_load_dwordx4 v[160:163], v18, s[56:59], 0 offen offset:0
    buffer_load_dwordx4 v[164:167], v18, s[56:59], 0 offen offset:16
    buffer_load_dwordx4 v[168:171], v18, s[56:59], 0 offen offset:32
    buffer_load_dwordx4 v[172:175], v18, s[56:59], 0 offen offset:48
    v_sub_u32 v100, 7, v24
    v_add_u32 v100, v100, v23
    v_and_b32 v100, 7, v100
    v_lshlrev_b32 v100, 4, v100
    v_lshl_add_u32 v100, v23, 10, v100
    v_add_u32 v100, s92, v100
    v_lshl_add_u32 v101, v24, 7, s92
    v_lshlrev_b32 v103, 4, v23
    v_lshl_add_u32 v102, v24, 12, v103
    s_lshl_b32 s101, s83, 5
    s_add_u32 s101, s101, s82
    s_lshl_b32 s101, s101, 7
    s_add_u32 s101, s101, 0x1558000
    s_lshl_b32 s89, s83, 18
    s_lshl_b32 s80, s82, 7
    s_add_u32 s89, s89, s80
    s_add_u32 s89, s89, 0xa00000
    s_mov_b32 s90, 0x05040100
    s_mov_b32 s91, 0x07060302
    s_mov_b32 s92, 0xffff0000
    s_branch L_common
L_i_no:
    v_mov_b32 v100, 0
    s_waitcnt lgkmcnt(0)
    s_barrier
    s_branch L_common
L_i_w1:
    s_mov_b32 s66, 2211840
    s_mov_b32 s67, 0x20000
    s_lshr_b32 s90, s93, 4
    s_bfe_u32 s91, s93, 0x20002
    s_and_b32 s93, s93, 3
    s_mul_i32 s80, s90, 13108
    s_lshr_b32 s80, s80, 16
    s_mul_i32 s81, s80, 5
    s_sub_u32 s81, s90, s81
    s_mul_i32 s80, s80, 160
    s_lshl_b32 s82, s81, 3
    s_cmp_gt_u32 s81, 2
    s_cselect_b32 s83, 56, 0
    s_add_u32 s82, s82, s83
    s_add_u32 s80, s80, s82
    s_mul_i32 s82, s91, 20
    s_add_u32 s80, s80, s82
    s_cmp_eq_u32 s81, 2
    s_cselect_b32 s83, 262656, 0
    s_mul_i32 s80, s80, 3456
    s_mul_i32 s81, s93, 864
    s_add_u32 s80, s80, s81
    s_waitcnt lgkmcnt(0)
    s_barrier
    s_bfm_b64 exec, 55, 0
    s_add_u32 m0, s92, 0
    s_add_u32 s82, s80, 0
    buffer_load_dwordx4 v2, s[64:67], s82 offen nt lds
    s_add_u32 m0, s92, 928
    s_add_u32 s82, s80, 3456
    buffer_load_dwordx4 v2, s[64:67], s82 offen nt lds
    s_add_u32 m0, s92, 1856
    s_add_u32 s82, s80, 6912
    buffer_load_dwordx4 v2, s[64:67], s82 offen nt lds
    s_add_u32 m0, s92, 2784
    s_add_u32 s82, s80, 10368
    buffer_load_dwordx4 v2, s[64:67], s82 offen nt lds
    s_add_u32 m0, s92, 3712
    s_add_u32 s82, s80, 13824
    s_add_u32 s82, s82, s83
    buffer_load_dwordx4 v2, s[64:67], s82 offen nt lds
    s_add_u32 m0, s92, 4640
    s_add_u32 s82, s80, 17280
    s_add_u32 s82, s82, s83
    buffer_load_dwordx4 v2, s[64:67], s82 offen nt lds
    s_add_u32 m0, s92, 5568
    s_add_u32 s82, s80, 20736
    s_add_u32 s82, s82, s83
    buffer_load_dwordx4 v2, s[64:67], s82 offen nt lds
    s_add_u32 m0, s92, 6496
    s_add_u32 s82, s80, 24192
    s_add_u32 s82, s82, s83
    buffer_load_dwordx4 v2, s[64:67], s82 offen nt lds
    s_mov_b64 exec, -1
    v_lshrrev_b32 v29, 4, v1
    v_bfe_u32 v30, v1, 2, 2
    v_and_b32 v31, 3, v1
    v_and_b32 v28, 15, v1
    v_mul_u32_u24 v100, 928, v30
    v_lshl_add_u32 v100, v31, 3, v100
    v_lshl_add_u32 v100, v29, 5, v100
    v_add_u32 v100, s92, v100
    v_lshlrev_b32 v104, 10, v29
    v_lshl_add_u32 v104, v28, 4, v104
    v_mov_b32 v27, 136192
    v_cmp_le_u32 vcc, 3, v29
    s_nop 1
    v_cndmask_b32 v26, 0, -8, vcc
    v_add_u32 v101, v100, v26
    v_cndmask_b32 v26, 0, v27, vcc
    v_add_u32 v105, v104, v26
    v_cmp_le_u32 vcc, 2, v29
    s_nop 1
    v_cndmask_b32 v26, 0, -8, vcc
    v_add_u32 v102, v100, v26
    v_cndmask_b32 v26, 0, v27, vcc
    v_add_u32 v106, v104, v26
    v_cmp_le_u32 vcc, 1, v29
    s_nop 1
    v_cndmask_b32 v26, 0, -8, vcc
    v_add_u32 v103, v100, v26
    v_cndmask_b32 v26, 0, v27, vcc
    v_add_u32 v107, v104, v26
    s_mul_i32 s89, s90, 7168
    s_lshl_b32 s80, s91, 8
    s_add_u32 s89, s89, s80
    s_mul_i32 s80, s93, 573440
    s_add_u32 s89, s89, s80
    s_add_u32 s89, s89, 0x1700000
    s_branch L_common
L_i_w2:
    s_mov_b32 s70, 2211840
    s_mov_b32 s71, 0x20000
    s_lshr_b32 s90, s93, 2
    s_and_b32 s91, s93, 3
    s_mul_i32 s82, s90, 9363
    s_lshr_b32 s82, s82, 16
    s_mul_i32 s83, s82, 7
    s_sub_u32 s83, s90, s83
    s_mul_i32 s82, s82, 216
    s_lshl_b32 s80, s83, 5
    s_add_u32 s82, s82, s80
    s_cmp_gt_u32 s83, 3
    s_cselect_b32 s80, -20, 0
    s_add_u32 s82, s82, s80
    s_lshl_b32 s80, s91, 2
    s_add_u32 s82, s82, s80
    s_cmp_eq_u32 s83, 3
    s_cselect_b32 s80, 108, 16
    s_cselect_b32 s83, s91, 0
    s_cmp_eq_u32 s83, 3
    s_cselect_b32 s83, 0x40000000, 0
    v_add_u32 v16, s83, v2
    s_mul_i32 s82, s82, 1280
    s_mul_i32 s80, s80, 1280
    s_add_u32 s80, s80, s82
    s_waitcnt lgkmcnt(0)
    s_barrier
    s_add_u32 m0, s92, 0
    s_add_u32 s81, s82, 4096
    buffer_load_dwordx4 v16, s[68:71], s82 offen offset:0 nt lds
    buffer_load_dwordx4 v16, s[68:71], s82 offen offset:1024 nt lds
    buffer_load_dwordx4 v16, s[68:71], s82 offen offset:2048 nt lds
    buffer_load_dwordx4 v16, s[68:71], s82 offen offset:3072 nt lds
    s_add_u32 m0, s92, 4096
    s_nop 0
    buffer_load_dwordx4 v16, s[68:71], s81 offen nt lds
    s_add_u32 m0, s92, 5120
    s_add_u32 s81, s80, 4096
    buffer_load_dwordx4 v16, s[68:71], s80 offen offset:0 nt lds
    buffer_load_dwordx4 v16, s[68:71], s80 offen offset:1024 nt lds
    buffer_load_dwordx4 v16, s[68:71], s80 offen offset:2048 nt lds
    buffer_load_dwordx4 v16, s[68:71], s80 offen offset:3072 nt lds
    s_add_u32 m0, s92, 9216
    s_nop 0
    buffer_load_dwordx4 v16, s[68:71], s81 offen nt lds
    v_lshrrev_b32 v29, 4, v1
    v_bfe_u32 v30, v1, 2, 2
    v_and_b32 v31, 3, v1
    v_and_b32 v28, 15, v1
    v_mul_u32_u24 v100, 1280, v30
    v_mul_u32_u24 v26, 40, v31
    v_mul_u32_u24 v27, 160, v29
    v_add3_u32 v100, v100, v26, v27
    v_add_u32 v100, s92, v100
    v_mul_u32_u24 v104, 17920, v29
    v_add_lshl_u32 v104, v104, v28, 4
    s_mul_i32 s89, s90, 5120
    s_lshl_b32 s80, s91, 8
    s_add_u32 s89, s89, s80
    s_add_u32 s89, s89, 0x1100000
L_common:
    s_and_b32 s3, s2, 7
    s_lshr_b32 s4, s2, 3
    s_mul_i32 s80, s3, 80
    s_lshr_b32 s81, s4, 1
    s_mul_i32 s81, s81, 5
    s_add_u32 s80, s80, s81
    s_add_u32 s25, s80, 4
    s_and_b32 s81, s4, 1
    s_lshl_b32 s81, s81, 1
    s_add_u32 s24, s80, s81
    s_lshl_b32 s83, s5, 10
    s_lshl_b32 s80, s24, 12
    s_add_u32 s81, s80, 4096
    s_lshl_b32 s82, s25, 12
    v_add_u32 v20, s83, v2
    v_cmp_eq_u32 vcc, 0, v20
    v_subrev_u32 v9, 16, v20
    s_mov_b32 s62, 2621440
    s_mov_b32 s63, 0x20000
    v_cndmask_b32 v9, v9, v125, vcc
    s_lshl_b32 s80, s24, 12
    s_add_u32 s81, s80, 4096
    s_lshl_b32 s82, s25, 12
    buffer_load_dwordx4 v[36:39], v20, s[60:63], s80 offen nt
    buffer_load_dwordx4 v[32:35], v9, s[60:63], s80 offen nt
    buffer_load_dwordx4 v[44:47], v20, s[60:63], s81 offen nt
    buffer_load_dwordx4 v[40:43], v9, s[60:63], s81 offen nt
    buffer_load_dwordx4 v[52:55], v20, s[60:63], s82 offen nt
    buffer_load_dwordx4 v[48:51], v9, s[60:63], s82 offen nt
    s_mov_b32 s34, 0x10000000
    s_mov_b32 s35, 0x20000
    s_mov_b32 s96, 0x154a000
    s_load_dword s13, s[32:33], s96
    s_and_b32 s96, s24, -2
    s_lshl_b32 s96, s96, 1
    s_load_dwordx2 s[72:73], s[30:31], s96
    s_and_b32 s96, s25, -2
    s_lshl_b32 s96, s96, 1
    s_load_dword s74, s[30:31], s96
    s_lshr_b32 s6, s4, 4
    s_and_b32 s7, s4, 15
    s_lshr_b32 s8, s4, 3
    s_and_b32 s9, s4, 7
    s_mov_b32 s10, 0
    s_mov_b32 s11, 0
    s_mov_b32 s12, 0
    s_getreg_b32 s75, hwreg(HW_REG_XCC_ID)
    s_and_b32 s75, s75, 15
    s_lshl_b32 s26, s3, 12
    s_add_u32 s26, s26, 0x1540000
    s_lshl_b32 s96, s3, 2
    s_add_u32 s96, s96, s8
    s_lshl_b32 s96, s96, 2
    s_add_u32 s96, s96, s5
    s_lshl_b32 s27, s96, 4
    v_and_b32 v190, 15, v1
    v_lshrrev_b32 v191, 4, v1
    v_mul_u32_u24 v14, 160, v190
    v_mul_u32_u24 v191, 40, v191
    s_mul_i32 s96, s5, 35840
    v_add3_u32 v14, v14, v191, s96
    v_mov_b32 v191, 0
    s_mov_b32 s46, 0x280000
    s_mov_b32 s47, 0x20000
    s_mov_b32 s42, 0xd80
    s_mov_b32 s43, 0x20000
    s_mov_b32 s38, 0x280000
    s_mov_b32 s39, 0x20000
    v_and_b32 v6, 15, v1
    v_lshrrev_b32 v7, 5, v1
    v_bfe_u32 v8, v1, 4, 1
    v_and_b32 v9, 7, v6
    v_mul_u32_u24 v9, 4256, v9
    v_lshrrev_b32 v10, 3, v6
    v_sub_u32 v10, v10, v7
    v_add_u32 v10, 1, v10
    v_lshl_add_u32 v9, v10, 4, v9
    v_mul_u32_u24 v10, 144, v6
    v_sub_u32 v4, 1, v7
    v_lshl_add_u32 v10, v4, 4, v10
    s_and_b32 s80, s4, 1
    s_cmp_eq_u32 s5, 3
    s_cselect_b32 s80, s80, 0
    s_cmp_eq_u32 s5, 2
    s_cselect_b32 s80, 1, s80
    s_xor_b32 s88, s80, 1
    v_lshlrev_b32 v113, 5, v1
    v_add_u32 v113, 0x1550000, v113
    s_lshl_b32 s77, s2, 5
    s_add_u32 s77, s77, 0x1550000
    s_cmp_lg_u32 s5, 0
    s_cselect_b32 s80, 0x40000000, 0
    v_mov_b32 v112, s80
    v_mov_b32 v5, 160016
    v_lshlrev_b32 v116, 7, v1
    s_lshl_b32 s80, s5, 9
    s_add_u32 s80, s80, s26
    s_add_u32 s80, s80, 1024
    v_cmp_gt_u32 vcc, 4, v1
    v_add_u32 v116, s80, v116
    s_nop 0
    v_cndmask_b32 v116, v125, v116, vcc
    s_mul_i32 s80, s5, 2176
    s_add_u32 s80, s80, 122880
    v_lshrrev_b32 v117, 4, v1
    v_mul_u32_u24 v118, 136, v6
    v_lshl_add_u32 v118, v117, 3, v118
    v_add_u32 v118, s80, v118
    v_mul_u32_u24 v119, 136, v117
    v_lshl_add_u32 v119, v6, 3, v119
    v_add_u32 v119, s80, v119
    s_mov_b32 s80, 163840
    v_mul_lo_u32 v120, v117, s80
    v_lshl_add_u32 v120, v6, 4, v120
    v_mul_u32_u24 v121, 144, v6
    v_lshlrev_b32 v122, 3, v117
    v_sub_u32 v121, v121, v122
    v_mul_u32_u24 v123, 6554, v1
    v_lshrrev_b32 v123, 16, v123
    v_mul_u32_u24 v124, 1120, v123
    v_add_u32 v123, v124, v2
    v_add_u32 v124, 64, v1
    v_mul_u32_u24 v124, 6554, v124
    v_lshrrev_b32 v124, 16, v124
    v_mul_u32_u24 v124, 1120, v124
    v_add_u32 v124, v124, v2
    v_add_u32 v124, 1024, v124
    v_add_u32 v126, 128, v1
    v_mul_u32_u24 v126, 6554, v126
    v_lshrrev_b32 v126, 16, v126
    v_mul_u32_u24 v126, 1120, v126
    v_add_u32 v126, v126, v2
    v_add_u32 v126, 2048, v126
    s_mul_i32 s78, s27, 1280
    s_mul_i32 s80, s9, 160
    s_add_u32 s78, s78, s80
    s_mul_i32 s79, s5, 2560
    s_add_u32 s79, s79, 131584
    v_mul_u32_u24 v127, 160, v6
    v_mul_u32_u24 v4, 40, v117
    v_add3_u32 v127, v127, v4, s79
    s_mul_i32 s76, s7, 143360
    s_mul_i32 s80, s5, 35840
    s_add_u32 s76, s76, s80
    s_add_u32 s76, s76, 0x1700000
    s_mul_i32 s80, s5, 35840
    v_add_u32 v188, s80, v2
    s_lshl_b32 s48, s3, 1
    s_add_u32 s48, s48, s6
    s_lshl_b32 s48, s48, 2
    s_add_u32 s48, s48, s5
    s_mul_i32 s48, s48, 114688
    s_lshr_b32 s80, s7, 1
    s_mul_i32 s80, s80, 7168
    s_add_u32 s48, s48, s80
    s_add_u32 s48, s48, 0xa00000
    s_and_b32 s80, s7, 1
    s_lshl_b32 s81, s80, 9
    s_add_u32 s50, s48, s81
    s_add_u32 s50, s50, 3072
    s_lshl_b32 s80, s80, 12
    s_add_u32 s48, s48, s80
    s_add_u32 s49, s48, 57344
    s_add_u32 s51, s50, 57344
    v_lshlrev_b32 v3, 3, v1
    v_mov_b32 v0, v3
    s_lshl_b32 s94, s2, 2
    s_add_u32 s94, s94, s5
    v_mul_u32_u24 v3, 7282, v1
    v_lshrrev_b32 v3, 16, v3
    v_mul_u32_u24 v4, 9, v3
    v_sub_u32 v4, v1, v4
    v_cmp_eq_u32 vcc, 8, v4
    v_lshlrev_b32 v3, 7, v3
    v_lshl_add_u32 v3, v4, 4, v3
    v_cndmask_b32 v111, v3, v125, vcc
    v_mul_u32_u24 v108, 9363, v1
    v_lshrrev_b32 v108, 16, v108
    v_mul_u32_u24 v109, 7, v108
    v_sub_u32 v109, v1, v109
    v_mul_u32_u24 v108, 4256, v108
    v_lshl_add_u32 v108, v109, 4, v108
    s_min_u32 s80, s5, 2
    s_mul_i32 s81, s80, 34048
    v_add_u32 v108, s81, v108
    s_mul_i32 s100, s80, 6768
    s_add_u32 s100, s100, 102144
    v_add_u32 v109, s100, v2
    s_and_b32 s80, s4, 1
    s_lshl_b32 s80, s80, 1
    s_sub_u32 s80, s24, s80
    s_lshr_b32 s80, s80, 6
    s_lshr_b32 s81, s25, 6
    s_sub_u32 s81, s81, s80
    v_and_b32 v110, 31, v1
    v_lshrrev_b32 v3, 5, v1
    v_mul_u32_u24 v3, s81, v3
    v_add_u32 v3, s80, v3
    v_lshl_add_u32 v110, v3, 5, v110
    v_lshlrev_b32 v110, 7, v110
    v_add_u32 v110, 0x1558000, v110
    v_add_u32 v21, 34048, v20
    v_add_u32 v22, 68096, v20
    s_waitcnt lgkmcnt(0)
    s_add_u32 s13, s13, 1
    v_mov_b32 v190, s13
    v_mov_b32 v114, s13
    v_mov_b32 v115, s75
    s_lshl_b32 s85, s72, 16
    s_and_b32 s86, s72, 0xffff0000
    s_lshl_b32 s80, s73, 16
    s_bitcmp1_b32 s24, 0
    s_cselect_b32 s85, s86, s85
    s_cselect_b32 s86, s80, s86
    s_lshl_b32 s87, s74, 16
    s_and_b32 s84, s74, 0xffff0000
    s_bitcmp1_b32 s25, 0
    s_cselect_b32 s87, s84, s87
    s_mul_i32 s73, s9, 286720
    s_mul_i32 s80, s5, 71680
    s_add_u32 s73, s73, s80
    s_add_u32 s73, s73, 0x1100000
    v_mov_b32 v176, 0
    v_mov_b32 v177, 0
    v_mov_b32 v178, 0
    v_mov_b32 v179, 0
    s_bfm_b64 exec, 56, 0
    ds_write_b128 v108, v[176:179]
    s_mov_b64 exec, -1
    ds_write_b128 v109, v[176:179]
    ds_write_b128 v109, v[176:179] offset:1024
    s_mov_b64 exec, 0x7f
    ds_write_b128 v109, v[176:179] offset:2048
    s_mov_b64 exec, -1
    v_mov_b32 v4, 160000
    s_cmp_lg_u32 s95, 0
    s_cbranch_scc1 L_nkv
    s_waitcnt vmcnt(6) lgkmcnt(0)
    v_perm_b32 v16, v56, v60, s90
    v_perm_b32 v17, v60, v64, s90
    v_perm_b32 v18, v64, v68, s90
    v_perm_b32 v19, v68, v72, s90
    v_perm_b32 v23, v72, v76, s90
    v_perm_b32 v24, v76, v80, s90
    v_perm_b32 v25, v80, v84, s90
    v_perm_b32 v28, v84, v88, s90
    v_perm_b32 v29, v88, v92, s90
    v_perm_b32 v30, v92, v96, s90
    v_dot2_f32_bf16 v176, v18, v160, 0
    v_dot2_f32_bf16 v177, v19, v160, 0
    v_dot2_f32_bf16 v178, v23, v160, 0
    v_dot2_f32_bf16 v179, v24, v160, 0
    v_dot2_f32_bf16 v180, v25, v160, 0
    v_dot2_f32_bf16 v181, v28, v160, 0
    v_dot2_f32_bf16 v182, v29, v160, 0
    v_dot2_f32_bf16 v183, v30, v160, 0
    v_dot2_f32_bf16 v176, v16, v161, v176
    v_dot2_f32_bf16 v177, v17, v161, v177
    v_dot2_f32_bf16 v178, v18, v161, v178
    v_dot2_f32_bf16 v179, v19, v161, v179
    v_dot2_f32_bf16 v180, v23, v161, v180
    v_dot2_f32_bf16 v181, v24, v161, v181
    v_dot2_f32_bf16 v182, v25, v161, v182
    v_dot2_f32_bf16 v183, v28, v161, v183
    v_lshlrev_b32 v16, 16, v128
    v_lshlrev_b32 v17, 16, v132
    v_lshlrev_b32 v18, 16, v136
    v_lshlrev_b32 v19, 16, v140
    v_lshlrev_b32 v24, 16, v144
    v_lshlrev_b32 v25, 16, v148
    v_lshlrev_b32 v28, 16, v152
    v_lshlrev_b32 v29, 16, v156
    v_pk_mul_f32 v[176:177], v[176:177], v[16:17]
    v_pk_mul_f32 v[178:179], v[178:179], v[18:19]
    v_pk_mul_f32 v[180:181], v[180:181], v[24:25]
    v_pk_mul_f32 v[182:183], v[182:183], v[28:29]
    v_cvt_pk_bf16_f32 v184, v183, v182
    v_cvt_pk_bf16_f32 v185, v181, v180
    v_cvt_pk_bf16_f32 v186, v179, v178
    v_cvt_pk_bf16_f32 v187, v177, v176
    ds_write_b128 v100, v[184:187] offset:0
    v_perm_b32 v16, v56, v60, s91
    v_perm_b32 v17, v60, v64, s91
    v_perm_b32 v18, v64, v68, s91
    v_perm_b32 v19, v68, v72, s91
    v_perm_b32 v23, v72, v76, s91
    v_perm_b32 v24, v76, v80, s91
    v_perm_b32 v25, v80, v84, s91
    v_perm_b32 v28, v84, v88, s91
    v_perm_b32 v29, v88, v92, s91
    v_perm_b32 v30, v92, v96, s91
    v_dot2_f32_bf16 v176, v18, v162, 0
    v_dot2_f32_bf16 v177, v19, v162, 0
    v_dot2_f32_bf16 v178, v23, v162, 0
    v_dot2_f32_bf16 v179, v24, v162, 0
    v_dot2_f32_bf16 v180, v25, v162, 0
    v_dot2_f32_bf16 v181, v28, v162, 0
    v_dot2_f32_bf16 v182, v29, v162, 0
    v_dot2_f32_bf16 v183, v30, v162, 0
    v_dot2_f32_bf16 v176, v16, v163, v176
    v_dot2_f32_bf16 v177, v17, v163, v177
    v_dot2_f32_bf16 v178, v18, v163, v178
    v_dot2_f32_bf16 v179, v19, v163, v179
    v_dot2_f32_bf16 v180, v23, v163, v180
    v_dot2_f32_bf16 v181, v24, v163, v181
    v_dot2_f32_bf16 v182, v25, v163, v182
    v_dot2_f32_bf16 v183, v28, v163, v183
    v_and_b32 v16, s92, v128
    v_and_b32 v17, s92, v132
    v_and_b32 v18, s92, v136
    v_and_b32 v19, s92, v140
    v_and_b32 v24, s92, v144
    v_and_b32 v25, s92, v148
    v_and_b32 v28, s92, v152
    v_and_b32 v29, s92, v156
    v_pk_mul_f32 v[176:177], v[176:177], v[16:17]
    v_pk_mul_f32 v[178:179], v[178:179], v[18:19]
    v_pk_mul_f32 v[180:181], v[180:181], v[24:25]
    v_pk_mul_f32 v[182:183], v[182:183], v[28:29]
    v_cvt_pk_bf16_f32 v184, v183, v182
    v_cvt_pk_bf16_f32 v185, v181, v180
    v_cvt_pk_bf16_f32 v186, v179, v178
    v_cvt_pk_bf16_f32 v187, v177, v176
    ds_write_b128 v100, v[184:187] offset:128
    v_perm_b32 v16, v57, v61, s90
    v_perm_b32 v17, v61, v65, s90
    v_perm_b32 v18, v65, v69, s90
    v_perm_b32 v19, v69, v73, s90
    v_perm_b32 v23, v73, v77, s90
    v_perm_b32 v24, v77, v81, s90
    v_perm_b32 v25, v81, v85, s90
    v_perm_b32 v28, v85, v89, s90
    v_perm_b32 v29, v89, v93, s90
    v_perm_b32 v30, v93, v97, s90
    v_dot2_f32_bf16 v176, v18, v164, 0
    v_dot2_f32_bf16 v177, v19, v164, 0
    v_dot2_f32_bf16 v178, v23, v164, 0
    v_dot2_f32_bf16 v179, v24, v164, 0
    v_dot2_f32_bf16 v180, v25, v164, 0
    v_dot2_f32_bf16 v181, v28, v164, 0
    v_dot2_f32_bf16 v182, v29, v164, 0
    v_dot2_f32_bf16 v183, v30, v164, 0
    v_dot2_f32_bf16 v176, v16, v165, v176
    v_dot2_f32_bf16 v177, v17, v165, v177
    v_dot2_f32_bf16 v178, v18, v165, v178
    v_dot2_f32_bf16 v179, v19, v165, v179
    v_dot2_f32_bf16 v180, v23, v165, v180
    v_dot2_f32_bf16 v181, v24, v165, v181
    v_dot2_f32_bf16 v182, v25, v165, v182
    v_dot2_f32_bf16 v183, v28, v165, v183
    v_lshlrev_b32 v16, 16, v129
    v_lshlrev_b32 v17, 16, v133
    v_lshlrev_b32 v18, 16, v137
    v_lshlrev_b32 v19, 16, v141
    v_lshlrev_b32 v24, 16, v145
    v_lshlrev_b32 v25, 16, v149
    v_lshlrev_b32 v28, 16, v153
    v_lshlrev_b32 v29, 16, v157
    v_pk_mul_f32 v[176:177], v[176:177], v[16:17]
    v_pk_mul_f32 v[178:179], v[178:179], v[18:19]
    v_pk_mul_f32 v[180:181], v[180:181], v[24:25]
    v_pk_mul_f32 v[182:183], v[182:183], v[28:29]
    v_cvt_pk_bf16_f32 v184, v183, v182
    v_cvt_pk_bf16_f32 v185, v181, v180
    v_cvt_pk_bf16_f32 v186, v179, v178
    v_cvt_pk_bf16_f32 v187, v177, v176
    ds_write_b128 v100, v[184:187] offset:256
    v_perm_b32 v16, v57, v61, s91
    v_perm_b32 v17, v61, v65, s91
    v_perm_b32 v18, v65, v69, s91
    v_perm_b32 v19, v69, v73, s91
    v_perm_b32 v23, v73, v77, s91
    v_perm_b32 v24, v77, v81, s91
    v_perm_b32 v25, v81, v85, s91
    v_perm_b32 v28, v85, v89, s91
    v_perm_b32 v29, v89, v93, s91
    v_perm_b32 v30, v93, v97, s91
    v_dot2_f32_bf16 v176, v18, v166, 0
    v_dot2_f32_bf16 v177, v19, v166, 0
    v_dot2_f32_bf16 v178, v23, v166, 0
    v_dot2_f32_bf16 v179, v24, v166, 0
    v_dot2_f32_bf16 v180, v25, v166, 0
    v_dot2_f32_bf16 v181, v28, v166, 0
    v_dot2_f32_bf16 v182, v29, v166, 0
    v_dot2_f32_bf16 v183, v30, v166, 0
    v_dot2_f32_bf16 v176, v16, v167, v176
    v_dot2_f32_bf16 v177, v17, v167, v177
    v_dot2_f32_bf16 v178, v18, v167, v178
    v_dot2_f32_bf16 v179, v19, v167, v179
    v_dot2_f32_bf16 v180, v23, v167, v180
    v_dot2_f32_bf16 v181, v24, v167, v181
    v_dot2_f32_bf16 v182, v25, v167, v182
    v_dot2_f32_bf16 v183, v28, v167, v183
    v_and_b32 v16, s92, v129
    v_and_b32 v17, s92, v133
    v_and_b32 v18, s92, v137
    v_and_b32 v19, s92, v141
    v_and_b32 v24, s92, v145
    v_and_b32 v25, s92, v149
    v_and_b32 v28, s92, v153
    v_and_b32 v29, s92, v157
    v_pk_mul_f32 v[176:177], v[176:177], v[16:17]
    v_pk_mul_f32 v[178:179], v[178:179], v[18:19]
    v_pk_mul_f32 v[180:181], v[180:181], v[24:25]
    v_pk_mul_f32 v[182:183], v[182:183], v[28:29]
    v_cvt_pk_bf16_f32 v184, v183, v182
    v_cvt_pk_bf16_f32 v185, v181, v180
    v_cvt_pk_bf16_f32 v186, v179, v178
    v_cvt_pk_bf16_f32 v187, v177, v176
    ds_write_b128 v100, v[184:187] offset:384
    v_perm_b32 v16, v58, v62, s90
    v_perm_b32 v17, v62, v66, s90
    v_perm_b32 v18, v66, v70, s90
    v_perm_b32 v19, v70, v74, s90
    v_perm_b32 v23, v74, v78, s90
    v_perm_b32 v24, v78, v82, s90
    v_perm_b32 v25, v82, v86, s90
    v_perm_b32 v28, v86, v90, s90
    v_perm_b32 v29, v90, v94, s90
    v_perm_b32 v30, v94, v98, s90
    v_dot2_f32_bf16 v176, v18, v168, 0
    v_dot2_f32_bf16 v177, v19, v168, 0
    v_dot2_f32_bf16 v178, v23, v168, 0
    v_dot2_f32_bf16 v179, v24, v168, 0
    v_dot2_f32_bf16 v180, v25, v168, 0
    v_dot2_f32_bf16 v181, v28, v168, 0
    v_dot2_f32_bf16 v182, v29, v168, 0
    v_dot2_f32_bf16 v183, v30, v168, 0
    v_dot2_f32_bf16 v176, v16, v169, v176
    v_dot2_f32_bf16 v177, v17, v169, v177
    v_dot2_f32_bf16 v178, v18, v169, v178
    v_dot2_f32_bf16 v179, v19, v169, v179
    v_dot2_f32_bf16 v180, v23, v169, v180
    v_dot2_f32_bf16 v181, v24, v169, v181
    v_dot2_f32_bf16 v182, v25, v169, v182
    v_dot2_f32_bf16 v183, v28, v169, v183
    v_lshlrev_b32 v16, 16, v130
    v_lshlrev_b32 v17, 16, v134
    v_lshlrev_b32 v18, 16, v138
    v_lshlrev_b32 v19, 16, v142
    v_lshlrev_b32 v24, 16, v146
    v_lshlrev_b32 v25, 16, v150
    v_lshlrev_b32 v28, 16, v154
    v_lshlrev_b32 v29, 16, v158
    v_pk_mul_f32 v[176:177], v[176:177], v[16:17]
    v_pk_mul_f32 v[178:179], v[178:179], v[18:19]
    v_pk_mul_f32 v[180:181], v[180:181], v[24:25]
    v_pk_mul_f32 v[182:183], v[182:183], v[28:29]
    v_cvt_pk_bf16_f32 v184, v183, v182
    v_cvt_pk_bf16_f32 v185, v181, v180
    v_cvt_pk_bf16_f32 v186, v179, v178
    v_cvt_pk_bf16_f32 v187, v177, v176
    ds_write_b128 v100, v[184:187] offset:512
    v_perm_b32 v16, v58, v62, s91
    v_perm_b32 v17, v62, v66, s91
    v_perm_b32 v18, v66, v70, s91
    v_perm_b32 v19, v70, v74, s91
    v_perm_b32 v23, v74, v78, s91
    v_perm_b32 v24, v78, v82, s91
    v_perm_b32 v25, v82, v86, s91
    v_perm_b32 v28, v86, v90, s91
    v_perm_b32 v29, v90, v94, s91
    v_perm_b32 v30, v94, v98, s91
    v_dot2_f32_bf16 v176, v18, v170, 0
    v_dot2_f32_bf16 v177, v19, v170, 0
    v_dot2_f32_bf16 v178, v23, v170, 0
    v_dot2_f32_bf16 v179, v24, v170, 0
    v_dot2_f32_bf16 v180, v25, v170, 0
    v_dot2_f32_bf16 v181, v28, v170, 0
    v_dot2_f32_bf16 v182, v29, v170, 0
    v_dot2_f32_bf16 v183, v30, v170, 0
    v_dot2_f32_bf16 v176, v16, v171, v176
    v_dot2_f32_bf16 v177, v17, v171, v177
    v_dot2_f32_bf16 v178, v18, v171, v178
    v_dot2_f32_bf16 v179, v19, v171, v179
    v_dot2_f32_bf16 v180, v23, v171, v180
    v_dot2_f32_bf16 v181, v24, v171, v181
    v_dot2_f32_bf16 v182, v25, v171, v182
    v_dot2_f32_bf16 v183, v28, v171, v183
    v_and_b32 v16, s92, v130
    v_and_b32 v17, s92, v134
    v_and_b32 v18, s92, v138
    v_and_b32 v19, s92, v142
    v_and_b32 v24, s92, v146
    v_and_b32 v25, s92, v150
    v_and_b32 v28, s92, v154
    v_and_b32 v29, s92, v158
    v_pk_mul_f32 v[176:177], v[176:177], v[16:17]
    v_pk_mul_f32 v[178:179], v[178:179], v[18:19]
    v_pk_mul_f32 v[180:181], v[180:181], v[24:25]
    v_pk_mul_f32 v[182:183], v[182:183], v[28:29]
    v_cvt_pk_bf16_f32 v184, v183, v182
    v_cvt_pk_bf16_f32 v185, v181, v180
    v_cvt_pk_bf16_f32 v186, v179, v178
    v_cvt_pk_bf16_f32 v187, v177, v176
    ds_write_b128 v100, v[184:187] offset:640
    v_perm_b32 v16, v59, v63, s90
    v_perm_b32 v17, v63, v67, s90
    v_perm_b32 v18, v67, v71, s90
    v_perm_b32 v19, v71, v75, s90
    v_perm_b32 v23, v75, v79, s90
    v_perm_b32 v24, v79, v83, s90
    v_perm_b32 v25, v83, v87, s90
    v_perm_b32 v28, v87, v91, s90
    v_perm_b32 v29, v91, v95, s90
    v_perm_b32 v30, v95, v99, s90
    v_dot2_f32_bf16 v176, v18, v172, 0
    v_dot2_f32_bf16 v177, v19, v172, 0
    v_dot2_f32_bf16 v178, v23, v172, 0
    v_dot2_f32_bf16 v179, v24, v172, 0
    v_dot2_f32_bf16 v180, v25, v172, 0
    v_dot2_f32_bf16 v181, v28, v172, 0
    v_dot2_f32_bf16 v182, v29, v172, 0
    v_dot2_f32_bf16 v183, v30, v172, 0
    v_dot2_f32_bf16 v176, v16, v173, v176
    v_dot2_f32_bf16 v177, v17, v173, v177
    v_dot2_f32_bf16 v178, v18, v173, v178
    v_dot2_f32_bf16 v179, v19, v173, v179
    v_dot2_f32_bf16 v180, v23, v173, v180
    v_dot2_f32_bf16 v181, v24, v173, v181
    v_dot2_f32_bf16 v182, v25, v173, v182
    v_dot2_f32_bf16 v183, v28, v173, v183
    v_lshlrev_b32 v16, 16, v131
    v_lshlrev_b32 v17, 16, v135
    v_lshlrev_b32 v18, 16, v139
    v_lshlrev_b32 v19, 16, v143
    v_lshlrev_b32 v24, 16, v147
    v_lshlrev_b32 v25, 16, v151
    v_lshlrev_b32 v28, 16, v155
    v_lshlrev_b32 v29, 16, v159
    v_pk_mul_f32 v[176:177], v[176:177], v[16:17]
    v_pk_mul_f32 v[178:179], v[178:179], v[18:19]
    v_pk_mul_f32 v[180:181], v[180:181], v[24:25]
    v_pk_mul_f32 v[182:183], v[182:183], v[28:29]
    v_cvt_pk_bf16_f32 v184, v183, v182
    v_cvt_pk_bf16_f32 v185, v181, v180
    v_cvt_pk_bf16_f32 v186, v179, v178
    v_cvt_pk_bf16_f32 v187, v177, v176
    ds_write_b128 v100, v[184:187] offset:768
    v_perm_b32 v16, v59, v63, s91
    v_perm_b32 v17, v63, v67, s91
    v_perm_b32 v18, v67, v71, s91
    v_perm_b32 v19, v71, v75, s91
    v_perm_b32 v23, v75, v79, s91
    v_perm_b32 v24, v79, v83, s91
    v_perm_b32 v25, v83, v87, s91
    v_perm_b32 v28, v87, v91, s91
    v_perm_b32 v29, v91, v95, s91
    v_perm_b32 v30, v95, v99, s91
    v_dot2_f32_bf16 v176, v18, v174, 0
    v_dot2_f32_bf16 v177, v19, v174, 0
    v_dot2_f32_bf16 v178, v23, v174, 0
    v_dot2_f32_bf16 v179, v24, v174, 0
    v_dot2_f32_bf16 v180, v25, v174, 0
    v_dot2_f32_bf16 v181, v28, v174, 0
    v_dot2_f32_bf16 v182, v29, v174, 0
    v_dot2_f32_bf16 v183, v30, v174, 0
    v_dot2_f32_bf16 v176, v16, v175, v176
    v_dot2_f32_bf16 v177, v17, v175, v177
    v_dot2_f32_bf16 v178, v18, v175, v178
    v_dot2_f32_bf16 v179, v19, v175, v179
    v_dot2_f32_bf16 v180, v23, v175, v180
    v_dot2_f32_bf16 v181, v24, v175, v181
    v_dot2_f32_bf16 v182, v25, v175, v182
    v_dot2_f32_bf16 v183, v28, v175, v183
    v_and_b32 v16, s92, v131
    v_and_b32 v17, s92, v135
    v_and_b32 v18, s92, v139
    v_and_b32 v19, s92, v143
    v_and_b32 v24, s92, v147
    v_and_b32 v25, s92, v151
    v_and_b32 v28, s92, v155
    v_and_b32 v29, s92, v159
    v_pk_mul_f32 v[176:177], v[176:177], v[16:17]
    v_pk_mul_f32 v[178:179], v[178:179], v[18:19]
    v_pk_mul_f32 v[180:181], v[180:181], v[24:25]
    v_pk_mul_f32 v[182:183], v[182:183], v[28:29]
    v_cvt_pk_bf16_f32 v184, v183, v182
    v_cvt_pk_bf16_f32 v185, v181, v180
    v_cvt_pk_bf16_f32 v186, v179, v178
    v_cvt_pk_bf16_f32 v187, v177, v176
    ds_write_b128 v100, v[184:187] offset:896
    v_add_u32 v16, 0, v103
    v_add_u32 v17, 16, v103
    v_add_u32 v18, 32, v103
    v_add_u32 v19, 48, v103
    v_add_u32 v24, 64, v103
    v_add_u32 v25, 80, v103
    v_add_u32 v28, 96, v103
    v_add_u32 v29, 112, v103
    v_and_b32 v16, 0x70, v16
    v_add_u32 v16, v101, v16
    v_and_b32 v17, 0x70, v17
    v_add_u32 v17, v101, v17
    v_and_b32 v18, 0x70, v18
    v_add_u32 v18, v101, v18
    v_and_b32 v19, 0x70, v19
    v_add_u32 v19, v101, v19
    v_and_b32 v24, 0x70, v24
    v_add_u32 v24, v101, v24
    v_and_b32 v25, 0x70, v25
    v_add_u32 v25, v101, v25
    v_and_b32 v28, 0x70, v28
    v_add_u32 v28, v101, v28
    v_and_b32 v29, 0x70, v29
    v_add_u32 v29, v101, v29
    s_waitcnt lgkmcnt(0)
    ds_read_b128 v[56:59], v16 offset:0
    ds_read_b128 v[60:63], v17 offset:1024
    ds_read_b128 v[64:67], v18 offset:2048
    ds_read_b128 v[68:71], v19 offset:3072
    ds_read_b128 v[72:75], v24 offset:4096
    ds_read_b128 v[76:79], v25 offset:5120
    ds_read_b128 v[80:83], v28 offset:6144
    ds_read_b128 v[84:87], v29 offset:7168
    s_waitcnt lgkmcnt(7)
    buffer_store_dwordx4 v[56:59], v102, s[32:35], s89 offen sc1
    s_add_u32 s89, s89, 32768
    s_waitcnt lgkmcnt(6)
    buffer_store_dwordx4 v[60:63], v102, s[32:35], s89 offen sc1
    s_add_u32 s89, s89, 32768
    s_waitcnt lgkmcnt(5)
    buffer_store_dwordx4 v[64:67], v102, s[32:35], s89 offen sc1
    s_add_u32 s89, s89, 32768
    s_waitcnt lgkmcnt(4)
    buffer_store_dwordx4 v[68:71], v102, s[32:35], s89 offen sc1
    s_add_u32 s89, s89, 32768
    s_waitcnt lgkmcnt(3)
    buffer_store_dwordx4 v[72:75], v102, s[32:35], s89 offen sc1
    s_add_u32 s89, s89, 32768
    s_waitcnt lgkmcnt(2)
    buffer_store_dwordx4 v[76:79], v102, s[32:35], s89 offen sc1
    s_add_u32 s89, s89, 32768
    s_waitcnt lgkmcnt(1)
    buffer_store_dwordx4 v[80:83], v102, s[32:35], s89 offen sc1
    s_add_u32 s89, s89, 32768
    s_waitcnt lgkmcnt(0)
    buffer_store_dwordx4 v[84:87], v102, s[32:35], s89 offen sc1
    s_waitcnt vmcnt(8)
    s_branch L_hp
L_nkv:
    s_waitcnt vmcnt(0)
L_hp:
    ds_write_b128 v20, v[36:39] offset:29904
    ds_write_b128 v20, v[34:37] offset:12880
    v_alignbit_b32 v150, v33, v32, 16
    v_alignbit_b32 v151, v34, v33, 16
    v_alignbit_b32 v152, v35, v34, 16
    v_alignbit_b32 v153, v36, v35, 16
    v_alignbit_b32 v154, v37, v36, 16
    v_alignbit_b32 v155, v38, v37, 16
    ds_write_b128 v20, v[150:153] offset:112
    ds_write_b128 v20, v[152:155] offset:17136
    v_alignbit_b32 v156, v34, v33, 16
    v_alignbit_b32 v157, v35, v34, 16
    v_alignbit_b32 v158, v36, v35, 16
    v_alignbit_b32 v159, v37, v36, 16
    v_alignbit_b32 v160, v38, v37, 16
    v_alignbit_b32 v161, v39, v38, 16
    ds_write_b128 v20, v[156:159] offset:8624
    ds_write_b128 v20, v[158:161] offset:25648
    v_mov_b32 v144, v33
    v_mov_b32 v145, v34
    v_mov_b32 v146, v35
    v_mov_b32 v147, v36
    v_mov_b32 v148, v37
    v_mov_b32 v149, v38
    ds_write_b128 v20, v[144:147] offset:4368
    ds_write_b128 v20, v[146:149] offset:21392
    s_cmp_eq_u32 s95, 0
    s_cbranch_scc1 ool_2
back_3:
    ds_write_b128 v21, v[44:47] offset:29904
    ds_write_b128 v21, v[42:45] offset:12880
    v_alignbit_b32 v168, v41, v40, 16
    v_alignbit_b32 v169, v42, v41, 16
    v_alignbit_b32 v170, v43, v42, 16
    v_alignbit_b32 v171, v44, v43, 16
    v_alignbit_b32 v172, v45, v44, 16
    v_alignbit_b32 v173, v46, v45, 16
    ds_write_b128 v21, v[168:171] offset:112
    ds_write_b128 v21, v[170:173] offset:17136
    v_alignbit_b32 v174, v42, v41, 16
    v_alignbit_b32 v175, v43, v42, 16
    v_alignbit_b32 v176, v44, v43, 16
    v_alignbit_b32 v177, v45, v44, 16
    v_alignbit_b32 v178, v46, v45, 16
    v_alignbit_b32 v179, v47, v46, 16
    ds_write_b128 v21, v[174:177] offset:8624
    ds_write_b128 v21, v[176:179] offset:25648
    v_mov_b32 v162, v41
    v_mov_b32 v163, v42
    v_mov_b32 v164, v43
    v_mov_b32 v165, v44
    v_mov_b32 v166, v45
    v_mov_b32 v167, v46
    ds_write_b128 v21, v[162:165] offset:4368
    ds_write_b128 v21, v[164:167] offset:21392
    s_waitcnt lgkmcnt(8)
    ds_write_b128 v22, v[52:55] offset:29904
    ds_write_b128 v22, v[50:53] offset:12880
    v_alignbit_b32 v150, v49, v48, 16
    v_alignbit_b32 v151, v50, v49, 16
    v_alignbit_b32 v152, v51, v50, 16
    v_alignbit_b32 v153, v52, v51, 16
    v_alignbit_b32 v154, v53, v52, 16
    v_alignbit_b32 v155, v54, v53, 16
    ds_write_b128 v22, v[150:153] offset:112
    ds_write_b128 v22, v[152:155] offset:17136
    v_alignbit_b32 v156, v50, v49, 16
    v_alignbit_b32 v157, v51, v50, 16
    v_alignbit_b32 v158, v52, v51, 16
    v_alignbit_b32 v159, v53, v52, 16
    v_alignbit_b32 v160, v54, v53, 16
    v_alignbit_b32 v161, v55, v54, 16
    ds_write_b128 v22, v[156:159] offset:8624
    ds_write_b128 v22, v[158:161] offset:25648
    v_mov_b32 v144, v49
    v_mov_b32 v145, v50
    v_mov_b32 v146, v51
    v_mov_b32 v147, v52
    v_mov_b32 v148, v53
    v_mov_b32 v149, v54
    ds_write_b128 v22, v[144:147] offset:4368
    ds_write_b128 v22, v[146:149] offset:21392
    s_waitcnt lgkmcnt(0)
    s_cmp_eq_u32 s95, 1
    s_cbranch_scc1 L_c_w1
    s_cmp_eq_u32 s95, 2
    s_cbranch_scc1 L_c_w2
    s_cmp_lg_u32 s95, 0
    s_cbranch_scc1 L_arr
    s_cmp_lg_u32 s5, 0
    s_cbranch_scc1 L_join
    s_sleep 16
    buffer_load_dword v56, v110, s[32:35], 0 offen sc1
    s_mov_b32 s97, 0
poll_4:
    s_waitcnt vmcnt(0)
    v_cmp_ne_u32 vcc, s13, v56
    s_cbranch_vccnz pretry_6
pdone_5:
    s_lshl_b32 s80, s24, 12
    s_add_u32 s80, s80, 0xa00000
    s_add_u32 s81, s80, 4096
    s_lshl_b32 s82, s25, 12
    s_add_u32 s82, s82, 0xa00000
    s_bfm_b64 exec, 63, 0
    s_mov_b32 m0, 104304
    s_add_u32 s83, s80, 0
    buffer_load_dwordx4 v111, s[32:35], s83 offen sc1 lds
    s_mov_b32 m0, 111072
    s_add_u32 s83, s81, 0
    buffer_load_dwordx4 v111, s[32:35], s83 offen sc1 lds
    s_mov_b32 m0, 117840
    s_add_u32 s83, s82, 0
    buffer_load_dwordx4 v111, s[32:35], s83 offen sc1 lds
    s_mov_b32 m0, 105312
    s_add_u32 s83, s80, 896
    buffer_load_dwordx4 v111, s[32:35], s83 offen sc1 lds
    s_mov_b32 m0, 112080
    s_add_u32 s83, s81, 896
    buffer_load_dwordx4 v111, s[32:35], s83 offen sc1 lds
    s_mov_b32 m0, 118848
    s_add_u32 s83, s82, 896
    buffer_load_dwordx4 v111, s[32:35], s83 offen sc1 lds
    s_mov_b32 m0, 106320
    s_add_u32 s83, s80, 1792
    buffer_load_dwordx4 v111, s[32:35], s83 offen sc1 lds
    s_mov_b32 m0, 113088
    s_add_u32 s83, s81, 1792
    buffer_load_dwordx4 v111, s[32:35], s83 offen sc1 lds
    s_mov_b32 m0, 119856
    s_add_u32 s83, s82, 1792
    buffer_load_dwordx4 v111, s[32:35], s83 offen sc1 lds
    s_mov_b32 m0, 107328
    s_add_u32 s83, s80, 2688
    buffer_load_dwordx4 v111, s[32:35], s83 offen sc1 lds
    s_mov_b32 m0, 114096
    s_add_u32 s83, s81, 2688
    buffer_load_dwordx4 v111, s[32:35], s83 offen sc1 lds
    s_mov_b32 m0, 120864
    s_add_u32 s83, s82, 2688
    buffer_load_dwordx4 v111, s[32:35], s83 offen sc1 lds
    s_bfm_b64 exec, 36, 0
    s_mov_b32 m0, 108336
    s_add_u32 s83, s80, 3584
    buffer_load_dwordx4 v111, s[32:35], s83 offen sc1 lds
    s_mov_b32 m0, 115104
    s_add_u32 s83, s81, 3584
    buffer_load_dwordx4 v111, s[32:35], s83 offen sc1 lds
    s_mov_b32 m0, 121872
    s_add_u32 s83, s82, 3584
    buffer_load_dwordx4 v111, s[32:35], s83 offen sc1 lds
    s_mov_b64 exec, -1
    s_waitcnt vmcnt(0)
    s_branch L_join
L_c_w1:
    ds_read_b64_tr_b16 a[0:1], v100 offset:0
    ds_read_b64_tr_b16 a[2:3], v100 offset:3712
    ds_read_b64_tr_b16 a[4:5], v101 offset:128
    ds_read_b64_tr_b16 a[6:7], v101 offset:3840
    ds_read_b64_tr_b16 a[8:9], v100 offset:248
    ds_read_b64_tr_b16 a[10:11], v100 offset:3960
    ds_read_b64_tr_b16 a[12:13], v102 offset:376
    ds_read_b64_tr_b16 a[14:15], v102 offset:4088
    ds_read_b64_tr_b16 a[16:17], v100 offset:496
    ds_read_b64_tr_b16 a[18:19], v100 offset:4208
    ds_read_b64_tr_b16 a[20:21], v103 offset:624
    ds_read_b64_tr_b16 a[22:23], v103 offset:4336
    ds_read_b64_tr_b16 a[24:25], v100 offset:744
    ds_read_b64_tr_b16 a[26:27], v100 offset:4456
    s_add_u32 s81, s89, 0
    s_waitcnt lgkmcnt(12)
    buffer_store_dwordx4 a[0:3], v104, s[32:35], s81 offen sc1
    s_add_u32 s81, s89, 4096
    s_waitcnt lgkmcnt(10)
    buffer_store_dwordx4 a[4:7], v105, s[32:35], s81 offen sc1
    s_add_u32 s81, s89, 144384
    s_waitcnt lgkmcnt(8)
    buffer_store_dwordx4 a[8:11], v104, s[32:35], s81 offen sc1
    s_add_u32 s81, s89, 148480
    s_waitcnt lgkmcnt(6)
    buffer_store_dwordx4 a[12:15], v106, s[32:35], s81 offen sc1
    s_add_u32 s81, s89, 288768
    s_waitcnt lgkmcnt(4)
    buffer_store_dwordx4 a[16:19], v104, s[32:35], s81 offen sc1
    s_add_u32 s81, s89, 292864
    s_waitcnt lgkmcnt(2)
    buffer_store_dwordx4 a[20:23], v107, s[32:35], s81 offen sc1
    s_add_u32 s81, s89, 433152
    s_waitcnt lgkmcnt(0)
    buffer_store_dwordx4 a[24:27], v104, s[32:35], s81 offen sc1
    s_branch L_arr
L_c_w2:
    ds_read_b64_tr_b16 a[0:1], v100 offset:0
    ds_read_b64_tr_b16 a[2:3], v100 offset:5120
    ds_read_b64_tr_b16 a[4:5], v100 offset:8
    ds_read_b64_tr_b16 a[6:7], v100 offset:5128
    ds_read_b64_tr_b16 a[8:9], v100 offset:16
    ds_read_b64_tr_b16 a[10:11], v100 offset:5136
    ds_read_b64_tr_b16 a[12:13], v100 offset:24
    ds_read_b64_tr_b16 a[14:15], v100 offset:5144
    ds_read_b64_tr_b16 a[16:17], v100 offset:32
    ds_read_b64_tr_b16 a[18:19], v100 offset:5152
    ds_read_b64_tr_b16 a[20:21], v100 offset:640
    ds_read_b64_tr_b16 a[22:23], v100 offset:5760
    ds_read_b64_tr_b16 a[24:25], v100 offset:648
    ds_read_b64_tr_b16 a[26:27], v100 offset:5768
    s_add_u32 s81, s89, 0
    s_waitcnt lgkmcnt(12)
    buffer_store_dwordx4 a[0:3], v104, s[32:35], s81 offen sc1
    ds_read_b64_tr_b16 a[28:29], v100 offset:656
    ds_read_b64_tr_b16 a[30:31], v100 offset:5776
    s_add_u32 s81, s89, 1024
    s_waitcnt lgkmcnt(12)
    buffer_store_dwordx4 a[4:7], v104, s[32:35], s81 offen sc1
    ds_read_b64_tr_b16 a[32:33], v100 offset:664
    ds_read_b64_tr_b16 a[34:35], v100 offset:5784
    s_add_u32 s81, s89, 2048
    s_waitcnt lgkmcnt(12)
    buffer_store_dwordx4 a[8:11], v104, s[32:35], s81 offen sc1
    ds_read_b64_tr_b16 a[36:37], v100 offset:672
    ds_read_b64_tr_b16 a[38:39], v100 offset:5792
    s_add_u32 s81, s89, 3072
    s_waitcnt lgkmcnt(12)
    buffer_store_dwordx4 a[12:15], v104, s[32:35], s81 offen sc1
    s_add_u32 s81, s89, 4096
    s_waitcnt lgkmcnt(10)
    buffer_store_dwordx4 a[16:19], v104, s[32:35], s81 offen sc1
    s_add_u32 s81, s89, 1146880
    s_waitcnt lgkmcnt(8)
    buffer_store_dwordx4 a[20:23], v104, s[32:35], s81 offen sc1
    s_add_u32 s81, s89, 1147904
    s_waitcnt lgkmcnt(6)
    buffer_store_dwordx4 a[24:27], v104, s[32:35], s81 offen sc1
    s_add_u32 s81, s89, 1148928
    s_waitcnt lgkmcnt(4)
    buffer_store_dwordx4 a[28:31], v104, s[32:35], s81 offen sc1
    s_add_u32 s81, s89, 1149952
    s_waitcnt lgkmcnt(2)
    buffer_store_dwordx4 a[32:35], v104, s[32:35], s81 offen sc1
    s_add_u32 s81, s89, 1150976
    s_waitcnt lgkmcnt(0)
    buffer_store_dwordx4 a[36:39], v104, s[32:35], s81 offen sc1
L_arr:
    s_waitcnt vmcnt(0)
    s_mov_b64 exec, 1
    v_mov_b32 v56, 1
    ds_add_rtn_u32 v56, v4, v56
    s_waitcnt lgkmcnt(0)
    v_cmp_eq_u32 vcc, 3, v56
    s_cbranch_vccz arr_8
    buffer_store_dwordx2 v[114:115], v191, s[32:35], s77 offen sc1
arr_8:
    s_mov_b64 exec, -1
L_join:
    s_barrier
    s_min_u32 s90, s5, 2
    s_cmp_eq_u32 s5, 2
    s_cselect_b32 s90, 0, s90
    s_lshl_b32 s91, s88, 4
    s_lshl_b32 s92, s88, 3
    s_add_u32 s92, s92, 8
    s_lshl_b32 s93, s88, 3
    s_mul_i32 s93, s93, 0
    s_mul_i32 s80, s90, 34048
    s_lshl_b32 s81, s93, 7
    s_add_u32 s80, s80, s81
    s_lshl_b32 s81, s92, 7
    v_mad_u32_u24 v3, v8, s81, v9
    v_add_u32 v3, s80, v3
    ds_read_b128 v[32:35], v3 offset:0
    ds_read_b128 v[36:39], v3 offset:32
    ds_read_b128 v[40:43], v3 offset:64
    ds_read_b128 v[44:47], v3 offset:96
    s_mul_i32 s80, s90, 6768
    s_sub_u32 s81, s91, s93
    s_add_u32 s81, s81, 8
    s_mul_i32 s81, s81, 144
    s_add_u32 s80, s80, s81
    s_add_u32 s80, s80, 102144
    s_mul_i32 s81, s92, 144
    v_mul_u32_u24 v4, s81, v8
    v_sub_u32 v4, v10, v4
    v_add_u32 v4, s80, v4
    ds_read_b128 v[64:67], v4 offset:1008
    ds_read_b128 v[48:51], v3 offset:128
    ds_read_b128 v[68:71], v4 offset:1040
    ds_read_b128 v[52:55], v3 offset:160
    ds_read_b128 v[72:75], v4 offset:1072
    ds_read_b128 v[56:59], v3 offset:192
    v_mov_b32 v16, 0
    v_mov_b32 v17, 0
    v_mov_b32 v18, 0
    v_mov_b32 v19, 0
    v_mov_b32 v20, 0
    v_mov_b32 v21, 0
    v_mov_b32 v22, 0
    v_mov_b32 v23, 0
    v_mov_b32 v24, 0
    v_mov_b32 v25, 0
    v_mov_b32 v26, 0
    v_mov_b32 v27, 0
    v_mov_b32 v28, 0
    v_mov_b32 v29, 0
    v_mov_b32 v30, 0
    v_mov_b32 v31, 0
    s_waitcnt lgkmcnt(5)
    v_mfma_f32_16x16x32_bf16 v[16:19], v[32:35], v[64:67], v[16:19]
    ds_read_b128 v[76:79], v4 offset:1104
    v_mfma_f32_16x16x32_bf16 v[20:23], v[36:39], v[64:67], v[20:23]
    ds_read_b128 v[60:63], v3 offset:224
    v_mfma_f32_16x16x32_bf16 v[24:27], v[40:43], v[64:67], v[24:27]
    v_mfma_f32_16x16x32_bf16 v[28:31], v[44:47], v[64:67], v[28:31]
    s_waitcnt lgkmcnt(5)
    v_mfma_f32_16x16x32_bf16 v[16:19], v[36:39], v[68:71], v[16:19]
    ds_read_b128 v[64:67], v4 offset:864
    v_mfma_f32_16x16x32_bf16 v[20:23], v[40:43], v[68:71], v[20:23]
    ds_read_b128 v[32:35], v3 offset:256
    v_mfma_f32_16x16x32_bf16 v[24:27], v[44:47], v[68:71], v[24:27]
    v_mfma_f32_16x16x32_bf16 v[28:31], v[48:51], v[68:71], v[28:31]
    s_waitcnt lgkmcnt(5)
    v_mfma_f32_16x16x32_bf16 v[16:19], v[40:43], v[72:75], v[16:19]
    ds_read_b128 v[68:71], v4 offset:896
    v_mfma_f32_16x16x32_bf16 v[20:23], v[44:47], v[72:75], v[20:23]
    ds_read_b128 v[36:39], v3 offset:288
    v_mfma_f32_16x16x32_bf16 v[24:27], v[48:51], v[72:75], v[24:27]
    v_mfma_f32_16x16x32_bf16 v[28:31], v[52:55], v[72:75], v[28:31]
    s_cmp_eq_u32 s5, 3
    s_cbranch_scc1 ool_9
back_10:
    s_waitcnt lgkmcnt(5)
    v_mfma_f32_16x16x32_bf16 v[16:19], v[44:47], v[76:79], v[16:19]
    ds_read_b128 v[72:75], v4 offset:928
    v_mfma_f32_16x16x32_bf16 v[20:23], v[48:51], v[76:79], v[20:23]
    ds_read_b128 v[40:43], v3 offset:320
    v_mfma_f32_16x16x32_bf16 v[24:27], v[52:55], v[76:79], v[24:27]
    v_mfma_f32_16x16x32_bf16 v[28:31], v[56:59], v[76:79], v[28:31]
    s_waitcnt lgkmcnt(5)
    v_mfma_f32_16x16x32_bf16 v[16:19], v[48:51], v[64:67], v[16:19]
    ds_read_b128 v[76:79], v4 offset:960
    v_mfma_f32_16x16x32_bf16 v[20:23], v[52:55], v[64:67], v[20:23]
    ds_read_b128 v[44:47], v3 offset:352
    v_mfma_f32_16x16x32_bf16 v[24:27], v[56:59], v[64:67], v[24:27]
    v_mfma_f32_16x16x32_bf16 v[28:31], v[60:63], v[64:67], v[28:31]
    s_mul_i32 s80, s90, 6768
    s_add_u32 s81, s91, 15
    s_waitcnt lgkmcnt(5)
    v_mfma_f32_16x16x32_bf16 v[16:19], v[52:55], v[68:71], v[16:19]
    ds_read_b128 v[64:67], v4 offset:720
    v_mfma_f32_16x16x32_bf16 v[20:23], v[56:59], v[68:71], v[20:23]
    ds_read_b128 v[48:51], v3 offset:384
    v_mfma_f32_16x16x32_bf16 v[24:27], v[60:63], v[68:71], v[24:27]
    v_mfma_f32_16x16x32_bf16 v[28:31], v[32:35], v[68:71], v[28:31]
    s_waitcnt lgkmcnt(5)
    v_mfma_f32_16x16x32_bf16 v[16:19], v[56:59], v[72:75], v[16:19]
    ds_read_b128 v[68:71], v4 offset:752
    v_mfma_f32_16x16x32_bf16 v[20:23], v[60:63], v[72:75], v[20:23]
    ds_read_b128 v[52:55], v3 offset:416
    v_mfma_f32_16x16x32_bf16 v[24:27], v[32:35], v[72:75], v[24:27]
    v_mfma_f32_16x16x32_bf16 v[28:31], v[36:39], v[72:75], v[28:31]
    s_mul_i32 s81, s81, 144
    s_add_u32 s80, s80, s81
    s_waitcnt lgkmcnt(5)
    v_mfma_f32_16x16x32_bf16 v[16:19], v[60:63], v[76:79], v[16:19]
    ds_read_b128 v[72:75], v4 offset:784
    v_mfma_f32_16x16x32_bf16 v[20:23], v[32:35], v[76:79], v[20:23]
    ds_read_b128 v[56:59], v3 offset:448
    v_mfma_f32_16x16x32_bf16 v[24:27], v[36:39], v[76:79], v[24:27]
    v_mfma_f32_16x16x32_bf16 v[28:31], v[40:43], v[76:79], v[28:31]
    s_waitcnt lgkmcnt(5)
    v_mfma_f32_16x16x32_bf16 v[16:19], v[32:35], v[64:67], v[16:19]
    ds_read_b128 v[76:79], v4 offset:816
    v_mfma_f32_16x16x32_bf16 v[20:23], v[36:39], v[64:67], v[20:23]
    ds_read_b128 v[60:63], v3 offset:480
    v_mfma_f32_16x16x32_bf16 v[24:27], v[40:43], v[64:67], v[24:27]
    v_mfma_f32_16x16x32_bf16 v[28:31], v[44:47], v[64:67], v[28:31]
    s_add_u32 s80, s80, 102168
    v_add_u32 v81, s80, v121
    s_cmp_lg_u32 s5, 3
    s_cbranch_scc1 pfw_11
    s_mov_b32 s97, 0
poll_12:
    s_waitcnt vmcnt(0)
    v_xor_b32 v108, s13, v100
    v_bitop3_b32 v108, v102, s13, v108 bitop3:0xbe
    v_bitop3_b32 v108, v104, s13, v108 bitop3:0xbe
    v_bitop3_b32 v108, v106, s13, v108 bitop3:0xbe
    v_cmp_ne_u32 vcc, 0, v108
    s_cbranch_vccnz pretry_14
pdone_13:
    v_xor_b32 v108, s75, v101
    v_bitop3_b32 v108, v103, s75, v108 bitop3:0xbe
    v_bitop3_b32 v108, v105, s75, v108 bitop3:0xbe
    v_bitop3_b32 v108, v107, s75, v108 bitop3:0xbe
    v_cmp_ne_u32 vcc, 0, v108
    v_and_b32 v109, 7, v1
    v_cmp_eq_u32 s[100:101], s3, v109
    s_nop 0
    s_and_b64 vcc, vcc, s[100:101]
    s_cmp_lg_u64 vcc, 0
    s_cselect_b32 s100, 1, 0
    v_mov_b32 v109, s100
    ds_write_b32 v5, v109
    s_waitcnt lgkmcnt(0)
    s_cmp_eq_u32 s94, 3
    s_cbranch_scc1 ool_16
back_17:
pfw_11:
    s_barrier
    s_waitcnt lgkmcnt(5)
    v_mfma_f32_16x16x32_bf16 v[16:19], v[36:39], v[68:71], v[16:19]
    ds_read_b128 v[64:67], v4 offset:576
    v_mfma_f32_16x16x32_bf16 v[20:23], v[40:43], v[68:71], v[20:23]
    ds_read_b128 v[32:35], v3 offset:512
    v_mfma_f32_16x16x32_bf16 v[24:27], v[44:47], v[68:71], v[24:27]
    v_mfma_f32_16x16x32_bf16 v[28:31], v[48:51], v[68:71], v[28:31]
    buffer_load_dword v104, v116, s[32:35], 0 offen sc1
    s_mov_b32 m0, s79
    s_nop 0
    buffer_load_dwordx4 v123, s[44:47], s78 offen nt lds
    s_waitcnt lgkmcnt(5)
    v_mfma_f32_16x16x32_bf16 v[16:19], v[40:43], v[72:75], v[16:19]
    ds_read_b128 v[68:71], v4 offset:608
    v_mfma_f32_16x16x32_bf16 v[20:23], v[44:47], v[72:75], v[20:23]
    ds_read_b128 v[36:39], v3 offset:544
    v_mfma_f32_16x16x32_bf16 v[24:27], v[48:51], v[72:75], v[24:27]
    v_mfma_f32_16x16x32_bf16 v[28:31], v[52:55], v[72:75], v[28:31]
    s_cmp_eq_u32 s90, 1
    s_cselect_b32 s80, s86, s85
    s_cselect_b32 s81, 1, 0
    s_add_u32 m0, s79, 1024
    s_nop 0
    buffer_load_dwordx4 v124, s[44:47], s78 offen nt lds
    s_add_u32 m0, s79, 2048
    s_bfm_b64 exec, 32, 0
    buffer_load_dwordx4 v126, s[44:47], s78 offen nt lds
    s_mov_b64 exec, -1
    s_waitcnt lgkmcnt(5)
    v_mfma_f32_16x16x32_bf16 v[16:19], v[44:47], v[76:79], v[16:19]
    ds_read_b128 v[72:75], v4 offset:640
    v_mfma_f32_16x16x32_bf16 v[20:23], v[48:51], v[76:79], v[20:23]
    ds_read_b128 v[40:43], v3 offset:576
    v_mfma_f32_16x16x32_bf16 v[24:27], v[52:55], v[76:79], v[24:27]
    buffer_load_dwordx4 a[112:115], v2, s[32:35], s76 offen offset:0 sc1
    v_mfma_f32_16x16x32_bf16 v[28:31], v[56:59], v[76:79], v[28:31]
    s_waitcnt lgkmcnt(5)
    v_mfma_f32_16x16x32_bf16 v[16:19], v[48:51], v[64:67], v[16:19]
    ds_read_b128 v[76:79], v4 offset:672
    v_mfma_f32_16x16x32_bf16 v[20:23], v[52:55], v[64:67], v[20:23]
    ds_read_b128 v[44:47], v3 offset:608
    v_mfma_f32_16x16x32_bf16 v[24:27], v[56:59], v[64:67], v[24:27]
    buffer_load_dwordx4 a[116:119], v2, s[32:35], s76 offen offset:1024 sc1
    v_mfma_f32_16x16x32_bf16 v[28:31], v[60:63], v[64:67], v[28:31]
    s_add_u32 s81, s81, s24
    s_mul_i32 s82, s91, 640
    s_waitcnt lgkmcnt(5)
    v_mfma_f32_16x16x32_bf16 v[16:19], v[52:55], v[68:71], v[16:19]
    ds_read_b128 v[64:67], v4 offset:432
    v_mfma_f32_16x16x32_bf16 v[20:23], v[56:59], v[68:71], v[20:23]
    ds_read_b128 v[48:51], v3 offset:640
    v_mfma_f32_16x16x32_bf16 v[24:27], v[60:63], v[68:71], v[24:27]
    v_mfma_f32_16x16x32_bf16 v[28:31], v[32:35], v[68:71], v[28:31]
    s_waitcnt lgkmcnt(5)
    v_mfma_f32_16x16x32_bf16 v[16:19], v[56:59], v[72:75], v[16:19]
    ds_read_b128 v[68:71], v4 offset:464
    v_mfma_f32_16x16x32_bf16 v[20:23], v[60:63], v[72:75], v[20:23]
    ds_read_b128 v[52:55], v3 offset:672
    v_mfma_f32_16x16x32_bf16 v[24:27], v[32:35], v[72:75], v[24:27]
    buffer_load_dwordx4 a[120:123], v2, s[32:35], s76 offen offset:2048 sc1
    v_mfma_f32_16x16x32_bf16 v[28:31], v[36:39], v[72:75], v[28:31]
    s_cmp_eq_u32 s90, 2
    s_cselect_b32 s80, s87, s80
    s_cselect_b32 s81, s25, s81
    s_waitcnt lgkmcnt(5)
    v_mfma_f32_16x16x32_bf16 v[16:19], v[60:63], v[76:79], v[16:19]
    ds_read_b128 v[72:75], v4 offset:496
    v_mfma_f32_16x16x32_bf16 v[20:23], v[32:35], v[76:79], v[20:23]
    ds_read_b128 v[56:59], v3 offset:704
    v_mfma_f32_16x16x32_bf16 v[24:27], v[36:39], v[76:79], v[24:27]
    v_mfma_f32_16x16x32_bf16 v[28:31], v[40:43], v[76:79], v[28:31]
    s_waitcnt lgkmcnt(5)
    v_mfma_f32_16x16x32_bf16 v[16:19], v[32:35], v[64:67], v[16:19]
    ds_read_b128 v[76:79], v4 offset:528
    v_mfma_f32_16x16x32_bf16 v[20:23], v[36:39], v[64:67], v[20:23]
    ds_read_b128 v[60:63], v3 offset:736
    v_mfma_f32_16x16x32_bf16 v[24:27], v[40:43], v[64:67], v[24:27]
    buffer_load_dwordx4 a[124:127], v2, s[32:35], s76 offen offset:3072 sc1
    v_mfma_f32_16x16x32_bf16 v[28:31], v[44:47], v[64:67], v[28:31]
    s_add_u32 s81, s81, s82
    s_lshl_b32 s81, s81, 8
    s_waitcnt lgkmcnt(5)
    v_mfma_f32_16x16x32_bf16 v[16:19], v[36:39], v[68:71], v[16:19]
    ds_read_b128 v[64:67], v4 offset:288
    v_mfma_f32_16x16x32_bf16 v[20:23], v[40:43], v[68:71], v[20:23]
    ds_read_b128 v[32:35], v3 offset:768
    v_mfma_f32_16x16x32_bf16 v[24:27], v[44:47], v[68:71], v[24:27]
    s_add_u32 s76, s76, 4096
    buffer_load_dwordx4 a[128:131], v2, s[32:35], s76 offen offset:0 sc1
    v_mfma_f32_16x16x32_bf16 v[28:31], v[48:51], v[68:71], v[28:31]
    s_waitcnt lgkmcnt(5)
    v_mfma_f32_16x16x32_bf16 v[16:19], v[40:43], v[72:75], v[16:19]
    ds_read_b128 v[68:71], v4 offset:320
    v_mfma_f32_16x16x32_bf16 v[20:23], v[44:47], v[72:75], v[20:23]
    ds_read_b128 v[36:39], v3 offset:800
    v_mfma_f32_16x16x32_bf16 v[24:27], v[48:51], v[72:75], v[24:27]
    v_mfma_f32_16x16x32_bf16 v[28:31], v[52:55], v[72:75], v[28:31]
    s_add_u32 s81, s81, 0x280000
    s_mov_b32 s82, 0xffff0000
    s_waitcnt lgkmcnt(5)
    v_mfma_f32_16x16x32_bf16 v[16:19], v[44:47], v[76:79], v[16:19]
    ds_read_b128 v[72:75], v4 offset:352
    v_mfma_f32_16x16x32_bf16 v[20:23], v[48:51], v[76:79], v[20:23]
    ds_read_b128 v[40:43], v3 offset:832
    v_mfma_f32_16x16x32_bf16 v[24:27], v[52:55], v[76:79], v[24:27]
    buffer_load_dwordx4 a[132:135], v2, s[32:35], s76 offen offset:1024 sc1
    v_mfma_f32_16x16x32_bf16 v[28:31], v[56:59], v[76:79], v[28:31]
    s_waitcnt lgkmcnt(5)
    v_mfma_f32_16x16x32_bf16 v[16:19], v[48:51], v[64:67], v[16:19]
    ds_read_b128 v[76:79], v4 offset:384
    v_mfma_f32_16x16x32_bf16 v[20:23], v[52:55], v[64:67], v[20:23]
    ds_read_b128 v[44:47], v3 offset:864
    v_mfma_f32_16x16x32_bf16 v[24:27], v[56:59], v[64:67], v[24:27]
    v_mfma_f32_16x16x32_bf16 v[28:31], v[60:63], v[64:67], v[28:31]
    v_mov_b32 v145, s13
    v_mov_b32 v147, s13
    v_mov_b32 v149, s13
    s_waitcnt lgkmcnt(5)
    v_mfma_f32_16x16x32_bf16 v[16:19], v[52:55], v[68:71], v[16:19]
    ds_read_b128 v[64:67], v4 offset:144
    v_mfma_f32_16x16x32_bf16 v[20:23], v[56:59], v[68:71], v[20:23]
    ds_read_b128 v[48:51], v3 offset:896
    v_mfma_f32_16x16x32_bf16 v[24:27], v[60:63], v[68:71], v[24:27]
    buffer_load_dwordx4 a[136:139], v2, s[32:35], s76 offen offset:2048 sc1
    v_mfma_f32_16x16x32_bf16 v[28:31], v[32:35], v[68:71], v[28:31]
    s_waitcnt lgkmcnt(5)
    v_mfma_f32_16x16x32_bf16 v[16:19], v[56:59], v[72:75], v[16:19]
    ds_read_b128 v[68:71], v4 offset:176
    v_mfma_f32_16x16x32_bf16 v[20:23], v[60:63], v[72:75], v[20:23]
    ds_read_b128 v[52:55], v3 offset:928
    v_mfma_f32_16x16x32_bf16 v[24:27], v[32:35], v[72:75], v[24:27]
    buffer_load_dwordx4 a[140:143], v2, s[32:35], s76 offen offset:3072 sc1
    v_mfma_f32_16x16x32_bf16 v[28:31], v[36:39], v[72:75], v[28:31]
    v_mov_b32 v151, s13
    v_mov_b32 v153, s13
    v_mov_b32 v155, s13
    s_waitcnt lgkmcnt(5)
    v_mfma_f32_16x16x32_bf16 v[16:19], v[60:63], v[76:79], v[16:19]
    ds_read_b128 v[72:75], v4 offset:208
    v_mfma_f32_16x16x32_bf16 v[20:23], v[32:35], v[76:79], v[20:23]
    ds_read_b128 v[56:59], v3 offset:960
    v_mfma_f32_16x16x32_bf16 v[24:27], v[36:39], v[76:79], v[24:27]
    v_mfma_f32_16x16x32_bf16 v[28:31], v[40:43], v[76:79], v[28:31]
    s_waitcnt lgkmcnt(5)
    v_mfma_f32_16x16x32_bf16 v[16:19], v[32:35], v[64:67], v[16:19]
    ds_read_b128 v[76:79], v4 offset:240
    v_mfma_f32_16x16x32_bf16 v[20:23], v[36:39], v[64:67], v[20:23]
    ds_read_b128 v[60:63], v3 offset:992
    v_mfma_f32_16x16x32_bf16 v[24:27], v[40:43], v[64:67], v[24:27]
    s_add_u32 s76, s76, 4096
    buffer_load_dwordx4 a[144:147], v2, s[32:35], s76 offen offset:0 sc1
    v_mfma_f32_16x16x32_bf16 v[28:31], v[44:47], v[64:67], v[28:31]
    v_mov_b32 v157, s13
    v_mov_b32 v159, s13
    s_waitcnt lgkmcnt(5)
    v_mfma_f32_16x16x32_bf16 v[16:19], v[36:39], v[68:71], v[16:19]
    ds_read_b128 v[64:67], v4 offset:0
    v_mfma_f32_16x16x32_bf16 v[20:23], v[40:43], v[68:71], v[20:23]
    ds_read_b128 v[32:35], v3 offset:1024
    v_mfma_f32_16x16x32_bf16 v[24:27], v[44:47], v[68:71], v[24:27]
    v_mfma_f32_16x16x32_bf16 v[28:31], v[48:51], v[68:71], v[28:31]
    s_waitcnt lgkmcnt(5)
    v_mfma_f32_16x16x32_bf16 v[16:19], v[40:43], v[72:75], v[16:19]
    ds_read_b128 v[68:71], v4 offset:32
    v_mfma_f32_16x16x32_bf16 v[20:23], v[44:47], v[72:75], v[20:23]
    ds_read_b128 v[36:39], v3 offset:1056
    v_mfma_f32_16x16x32_bf16 v[24:27], v[48:51], v[72:75], v[24:27]
    buffer_load_dwordx4 a[148:151], v2, s[32:35], s76 offen offset:1024 sc1
    v_mfma_f32_16x16x32_bf16 v[28:31], v[52:55], v[72:75], v[28:31]
    ds_read_b64 v[84:85], v81 offset:96
    ds_read_b64 v[86:87], v81 offset:64
    ds_read_b64 v[88:89], v81 offset:32
    ds_read_b64 v[90:91], v81 offset:0
    s_waitcnt lgkmcnt(9)
    v_mfma_f32_16x16x32_bf16 v[16:19], v[44:47], v[76:79], v[16:19]
    ds_read_b128 v[72:75], v4 offset:64
    v_mfma_f32_16x16x32_bf16 v[20:23], v[48:51], v[76:79], v[20:23]
    ds_read_b128 v[40:43], v3 offset:1088
    v_mfma_f32_16x16x32_bf16 v[24:27], v[52:55], v[76:79], v[24:27]
    buffer_load_dwordx4 a[152:155], v2, s[32:35], s76 offen offset:2048 sc1
    v_mfma_f32_16x16x32_bf16 v[28:31], v[56:59], v[76:79], v[28:31]
    s_waitcnt lgkmcnt(9)
    v_mfma_f32_16x16x32_bf16 v[16:19], v[48:51], v[64:67], v[16:19]
    ds_read_b128 v[76:79], v4 offset:96
    v_mfma_f32_16x16x32_bf16 v[20:23], v[52:55], v[64:67], v[20:23]
    v_mfma_f32_16x16x32_bf16 v[24:27], v[56:59], v[64:67], v[24:27]
    v_mfma_f32_16x16x32_bf16 v[28:31], v[60:63], v[64:67], v[28:31]
    s_waitcnt lgkmcnt(8)
    v_mfma_f32_16x16x32_bf16 v[16:19], v[52:55], v[68:71], v[16:19]
    v_mfma_f32_16x16x32_bf16 v[20:23], v[56:59], v[68:71], v[20:23]
    v_mfma_f32_16x16x32_bf16 v[24:27], v[60:63], v[68:71], v[24:27]
    buffer_load_dwordx4 a[156:159], v2, s[32:35], s76 offen offset:3072 sc1
    v_mfma_f32_16x16x32_bf16 v[28:31], v[32:35], v[68:71], v[28:31]
    s_waitcnt lgkmcnt(2)
    v_mfma_f32_16x16x32_bf16 v[16:19], v[56:59], v[72:75], v[16:19]
    v_mfma_f32_16x16x32_bf16 v[20:23], v[60:63], v[72:75], v[20:23]
    v_and_b32 v128, s82, v85
    v_lshlrev_b32 v129, 16, v85
    v_and_b32 v130, s82, v84
    v_mfma_f32_16x16x32_bf16 v[24:27], v[32:35], v[72:75], v[24:27]
    v_lshlrev_b32 v131, 16, v84
    v_and_b32 v132, s82, v87
    v_lshlrev_b32 v133, 16, v87
    v_mfma_f32_16x16x32_bf16 v[28:31], v[36:39], v[72:75], v[28:31]
    v_and_b32 v134, s82, v86
    v_lshlrev_b32 v135, 16, v86
    v_and_b32 v136, s82, v89
    s_waitcnt lgkmcnt(0)
    v_mfma_f32_16x16x32_bf16 v[16:19], v[60:63], v[76:79], v[16:19]
    v_mfma_f32_16x16x32_bf16 v[20:23], v[32:35], v[76:79], v[20:23]
    v_lshlrev_b32 v137, 16, v89
    v_and_b32 v138, s82, v88
    v_lshlrev_b32 v139, 16, v88
    v_mfma_f32_16x16x32_bf16 v[24:27], v[36:39], v[76:79], v[24:27]
    s_add_u32 s76, s76, 4096
    buffer_load_dwordx4 a[160:163], v2, s[32:35], s76 offen offset:0 sc1
    v_and_b32 v140, s82, v91
    v_lshlrev_b32 v141, 16, v91
    v_and_b32 v142, s82, v90
    v_mfma_f32_16x16x32_bf16 v[28:31], v[40:43], v[76:79], v[28:31]
    v_lshlrev_b32 v143, 16, v90
    s_cmp_lg_u32 s88, 0
    s_cbranch_scc1 L_noepi
    v_fmac_f32 v16, s80, v128
    v_fmac_f32 v17, s80, v129
    v_fmac_f32 v18, s80, v130
    v_fmac_f32 v19, s80, v131
    v_cvt_pk_bf16_f32 v92, v16, v17
    v_cvt_pk_bf16_f32 v93, v18, v19
    ds_write_b64 v118, v[92:93] offset:0
    v_fmac_f32 v20, s80, v132
    v_fmac_f32 v21, s80, v133
    v_fmac_f32 v22, s80, v134
    v_fmac_f32 v23, s80, v135
    v_cvt_pk_bf16_f32 v94, v20, v21
    v_cvt_pk_bf16_f32 v95, v22, v23
    ds_write_b64 v118, v[94:95] offset:32
    v_fmac_f32 v24, s80, v136
    v_fmac_f32 v25, s80, v137
    v_fmac_f32 v26, s80, v138
    v_fmac_f32 v27, s80, v139
    v_cvt_pk_bf16_f32 v96, v24, v25
    v_cvt_pk_bf16_f32 v97, v26, v27
    ds_write_b64 v118, v[96:97] offset:64
    v_fmac_f32 v28, s80, v140
    v_fmac_f32 v29, s80, v141
    v_fmac_f32 v30, s80, v142
    v_fmac_f32 v31, s80, v143
    v_cvt_pk_bf16_f32 v98, v28, v29
    v_cvt_pk_bf16_f32 v99, v30, v31
    ds_write_b64 v118, v[98:99] offset:96
    s_waitcnt lgkmcnt(0)
    ds_read_b32 v144, v119 offset:0
    ds_read_b32 v146, v119 offset:4
    ds_read_b32 v148, v119 offset:544
    ds_read_b32 v150, v119 offset:548
    ds_read_b32 v152, v119 offset:1088
    ds_read_b32 v154, v119 offset:1092
    ds_read_b32 v156, v119 offset:1632
    ds_read_b32 v158, v119 offset:1636
    s_waitcnt lgkmcnt(6)
    buffer_store_dwordx4 v[144:147], v120, s[32:35], s81 offen sc1
    s_add_u32 s81, s81, 655360
    s_waitcnt lgkmcnt(4)
    buffer_store_dwordx4 v[148:151], v120, s[32:35], s81 offen sc1
    s_add_u32 s81, s81, 655360
    s_waitcnt lgkmcnt(2)
    buffer_store_dwordx4 v[152:155], v120, s[32:35], s81 offen sc1
    s_add_u32 s81, s81, 655360
    s_waitcnt lgkmcnt(0)
    buffer_store_dwordx4 v[156:159], v120, s[32:35], s81 offen sc1
L_noepi:
    s_cmp_eq_u32 s5, 3
    s_cselect_b32 s80, s88, 1
    s_cmp_lg_u32 s80, 0
    s_cbranch_scc1 L_half1
    buffer_load_dwordx4 a[164:167], v2, s[32:35], s76 offen offset:1024 sc1
    buffer_load_dwordx4 a[168:171], v2, s[32:35], s76 offen offset:2048 sc1
    buffer_load_dwordx4 a[172:175], v2, s[32:35], s76 offen offset:3072 sc1
    s_add_u32 s76, s76, 4096
    buffer_load_dwordx4 a[176:179], v2, s[32:35], s76 offen offset:0 sc1
    buffer_load_dwordx4 a[180:183], v2, s[32:35], s76 offen offset:1024 sc1
    buffer_load_dwordx4 a[184:187], v2, s[32:35], s76 offen offset:2048 sc1
    buffer_load_dwordx4 a[188:191], v2, s[32:35], s76 offen offset:3072 sc1
    s_add_u32 s76, s76, 4096
    buffer_load_dwordx4 a[192:195], v2, s[32:35], s76 offen offset:0 sc1
    buffer_load_dwordx4 a[196:199], v2, s[32:35], s76 offen offset:1024 sc1
    buffer_load_dwordx4 a[200:203], v2, s[32:35], s76 offen offset:2048 sc1
    buffer_load_dwordx4 a[204:207], v2, s[32:35], s76 offen offset:3072 sc1
    s_add_u32 s76, s76, 4096
    buffer_load_dwordx4 a[208:211], v2, s[32:35], s76 offen offset:0 sc1
    buffer_load_dwordx4 a[212:215], v2, s[32:35], s76 offen offset:1024 sc1
    buffer_load_dwordx4 a[216:219], v2, s[32:35], s76 offen offset:2048 sc1
    buffer_load_dwordx4 a[220:223], v2, s[32:35], s76 offen offset:3072 sc1
    s_add_u32 s76, s76, 4096
    buffer_load_dwordx4 a[224:227], v2, s[32:35], s76 offen offset:0 sc1
    buffer_load_dwordx4 a[228:231], v2, s[32:35], s76 offen offset:1024 sc1
    buffer_load_dwordx4 a[232:235], v2, s[32:35], s76 offen offset:2048 sc1
    buffer_load_dwordx4 a[236:239], v2, s[32:35], s76 offen offset:3072 sc1
    s_waitcnt vmcnt(0)
    s_branch L_p1_done
L_half1:
    s_min_u32 s90, s5, 2
    s_cmp_eq_u32 s5, 2
    s_cselect_b32 s90, 1, s90
    s_lshl_b32 s91, s88, 4
    s_lshl_b32 s92, s88, 3
    s_add_u32 s92, s92, 8
    s_lshl_b32 s93, s88, 3
    s_mul_i32 s93, s93, 1
    s_mul_i32 s80, s90, 34048
    s_lshl_b32 s81, s93, 7
    s_add_u32 s80, s80, s81
    s_lshl_b32 s81, s92, 7
    v_mad_u32_u24 v3, v8, s81, v9
    v_add_u32 v3, s80, v3
    ds_read_b128 v[32:35], v3 offset:0
    ds_read_b128 v[36:39], v3 offset:32
    ds_read_b128 v[40:43], v3 offset:64
    ds_read_b128 v[44:47], v3 offset:96
    s_mul_i32 s80, s90, 6768
    s_sub_u32 s81, s91, s93
    s_add_u32 s81, s81, 8
    s_mul_i32 s81, s81, 144
    s_add_u32 s80, s80, s81
    s_add_u32 s80, s80, 102144
    s_mul_i32 s81, s92, 144
    v_mul_u32_u24 v4, s81, v8
    v_sub_u32 v4, v10, v4
    v_add_u32 v4, s80, v4
    ds_read_b128 v[64:67], v4 offset:1008
    ds_read_b128 v[48:51], v3 offset:128
    ds_read_b128 v[68:71], v4 offset:1040
    ds_read_b128 v[52:55], v3 offset:160
    ds_read_b128 v[72:75], v4 offset:1072
    ds_read_b128 v[56:59], v3 offset:192
    s_cmp_lg_u32 s93, 0
    s_cbranch_scc1 L_noz
    v_mov_b32 v16, 0
    v_mov_b32 v17, 0
    v_mov_b32 v18, 0
    v_mov_b32 v19, 0
    v_mov_b32 v20, 0
    v_mov_b32 v21, 0
    v_mov_b32 v22, 0
    v_mov_b32 v23, 0
    v_mov_b32 v24, 0
    v_mov_b32 v25, 0
    v_mov_b32 v26, 0
    v_mov_b32 v27, 0
    v_mov_b32 v28, 0
    v_mov_b32 v29, 0
    v_mov_b32 v30, 0
    v_mov_b32 v31, 0
L_noz:
    s_waitcnt lgkmcnt(5)
    v_mfma_f32_16x16x32_bf16 v[16:19], v[32:35], v[64:67], v[16:19]
    ds_read_b128 v[76:79], v4 offset:1104
    v_mfma_f32_16x16x32_bf16 v[20:23], v[36:39], v[64:67], v[20:23]
    ds_read_b128 v[60:63], v3 offset:224
    v_mfma_f32_16x16x32_bf16 v[24:27], v[40:43], v[64:67], v[24:27]
    v_mfma_f32_16x16x32_bf16 v[28:31], v[44:47], v[64:67], v[28:31]
    s_waitcnt lgkmcnt(5)
    v_mfma_f32_16x16x32_bf16 v[16:19], v[36:39], v[68:71], v[16:19]
    ds_read_b128 v[64:67], v4 offset:864
    v_mfma_f32_16x16x32_bf16 v[20:23], v[40:43], v[68:71], v[20:23]
    ds_read_b128 v[32:35], v3 offset:256
    v_mfma_f32_16x16x32_bf16 v[24:27], v[44:47], v[68:71], v[24:27]
    buffer_load_dwordx4 a[164:167], v2, s[32:35], s76 offen offset:1024 sc1
    v_mfma_f32_16x16x32_bf16 v[28:31], v[48:51], v[68:71], v[28:31]
    s_waitcnt lgkmcnt(5)
    v_mfma_f32_16x16x32_bf16 v[16:19], v[40:43], v[72:75], v[16:19]
    ds_read_b128 v[68:71], v4 offset:896
    v_mfma_f32_16x16x32_bf16 v[20:23], v[44:47], v[72:75], v[20:23]
    ds_read_b128 v[36:39], v3 offset:288
    v_mfma_f32_16x16x32_bf16 v[24:27], v[48:51], v[72:75], v[24:27]
    buffer_load_dwordx4 a[168:171], v2, s[32:35], s76 offen offset:2048 sc1
    v_mfma_f32_16x16x32_bf16 v[28:31], v[52:55], v[72:75], v[28:31]
    s_waitcnt lgkmcnt(5)
    v_mfma_f32_16x16x32_bf16 v[16:19], v[44:47], v[76:79], v[16:19]
    ds_read_b128 v[72:75], v4 offset:928
    v_mfma_f32_16x16x32_bf16 v[20:23], v[48:51], v[76:79], v[20:23]
    ds_read_b128 v[40:43], v3 offset:320
    v_mfma_f32_16x16x32_bf16 v[24:27], v[52:55], v[76:79], v[24:27]
    v_mfma_f32_16x16x32_bf16 v[28:31], v[56:59], v[76:79], v[28:31]
    s_waitcnt lgkmcnt(5)
    v_mfma_f32_16x16x32_bf16 v[16:19], v[48:51], v[64:67], v[16:19]
    ds_read_b128 v[76:79], v4 offset:960
    v_mfma_f32_16x16x32_bf16 v[20:23], v[52:55], v[64:67], v[20:23]
    ds_read_b128 v[44:47], v3 offset:352
    v_mfma_f32_16x16x32_bf16 v[24:27], v[56:59], v[64:67], v[24:27]
    buffer_load_dwordx4 a[172:175], v2, s[32:35], s76 offen offset:3072 sc1
    v_mfma_f32_16x16x32_bf16 v[28:31], v[60:63], v[64:67], v[28:31]
    s_mul_i32 s80, s90, 6768
    s_add_u32 s81, s91, 15
    s_waitcnt lgkmcnt(5)
    v_mfma_f32_16x16x32_bf16 v[16:19], v[52:55], v[68:71], v[16:19]
    ds_read_b128 v[64:67], v4 offset:720
    v_mfma_f32_16x16x32_bf16 v[20:23], v[56:59], v[68:71], v[20:23]
    ds_read_b128 v[48:51], v3 offset:384
    v_mfma_f32_16x16x32_bf16 v[24:27], v[60:63], v[68:71], v[24:27]
    v_mfma_f32_16x16x32_bf16 v[28:31], v[32:35], v[68:71], v[28:31]
    s_waitcnt lgkmcnt(5)
    v_mfma_f32_16x16x32_bf16 v[16:19], v[56:59], v[72:75], v[16:19]
    ds_read_b128 v[68:71], v4 offset:752
    v_mfma_f32_16x16x32_bf16 v[20:23], v[60:63], v[72:75], v[20:23]
    ds_read_b128 v[52:55], v3 offset:416
    v_mfma_f32_16x16x32_bf16 v[24:27], v[32:35], v[72:75], v[24:27]
    s_add_u32 s76, s76, 4096
    buffer_load_dwordx4 a[176:179], v2, s[32:35], s76 offen offset:0 sc1
    v_mfma_f32_16x16x32_bf16 v[28:31], v[36:39], v[72:75], v[28:31]
    s_mul_i32 s81, s81, 144
    s_add_u32 s80, s80, s81
    s_waitcnt lgkmcnt(5)
    v_mfma_f32_16x16x32_bf16 v[16:19], v[60:63], v[76:79], v[16:19]
    ds_read_b128 v[72:75], v4 offset:784
    v_mfma_f32_16x16x32_bf16 v[20:23], v[32:35], v[76:79], v[20:23]
    ds_read_b128 v[56:59], v3 offset:448
    v_mfma_f32_16x16x32_bf16 v[24:27], v[36:39], v[76:79], v[24:27]
    buffer_load_dwordx4 a[180:183], v2, s[32:35], s76 offen offset:1024 sc1
    v_mfma_f32_16x16x32_bf16 v[28:31], v[40:43], v[76:79], v[28:31]
    s_waitcnt lgkmcnt(5)
    v_mfma_f32_16x16x32_bf16 v[16:19], v[32:35], v[64:67], v[16:19]
    ds_read_b128 v[76:79], v4 offset:816
    v_mfma_f32_16x16x32_bf16 v[20:23], v[36:39], v[64:67], v[20:23]
    ds_read_b128 v[60:63], v3 offset:480
    v_mfma_f32_16x16x32_bf16 v[24:27], v[40:43], v[64:67], v[24:27]
    v_mfma_f32_16x16x32_bf16 v[28:31], v[44:47], v[64:67], v[28:31]
    s_add_u32 s80, s80, 102168
    v_add_u32 v81, s80, v121
    s_waitcnt lgkmcnt(5)
    v_mfma_f32_16x16x32_bf16 v[16:19], v[36:39], v[68:71], v[16:19]
    ds_read_b128 v[64:67], v4 offset:576
    v_mfma_f32_16x16x32_bf16 v[20:23], v[40:43], v[68:71], v[20:23]
    ds_read_b128 v[32:35], v3 offset:512
    v_mfma_f32_16x16x32_bf16 v[24:27], v[44:47], v[68:71], v[24:27]
    buffer_load_dwordx4 a[184:187], v2, s[32:35], s76 offen offset:2048 sc1
    v_mfma_f32_16x16x32_bf16 v[28:31], v[48:51], v[68:71], v[28:31]
    s_waitcnt lgkmcnt(5)
    v_mfma_f32_16x16x32_bf16 v[16:19], v[40:43], v[72:75], v[16:19]
    ds_read_b128 v[68:71], v4 offset:608
    v_mfma_f32_16x16x32_bf16 v[20:23], v[44:47], v[72:75], v[20:23]
    ds_read_b128 v[36:39], v3 offset:544
    v_mfma_f32_16x16x32_bf16 v[24:27], v[48:51], v[72:75], v[24:27]
    v_mfma_f32_16x16x32_bf16 v[28:31], v[52:55], v[72:75], v[28:31]
    s_cmp_eq_u32 s90, 1
    s_cselect_b32 s80, s86, s85
    s_cselect_b32 s81, 1, 0
    s_waitcnt lgkmcnt(5)
    v_mfma_f32_16x16x32_bf16 v[16:19], v[44:47], v[76:79], v[16:19]
    ds_read_b128 v[72:75], v4 offset:640
    v_mfma_f32_16x16x32_bf16 v[20:23], v[48:51], v[76:79], v[20:23]
    ds_read_b128 v[40:43], v3 offset:576
    v_mfma_f32_16x16x32_bf16 v[24:27], v[52:55], v[76:79], v[24:27]
    buffer_load_dwordx4 a[188:191], v2, s[32:35], s76 offen offset:3072 sc1
    v_mfma_f32_16x16x32_bf16 v[28:31], v[56:59], v[76:79], v[28:31]
    s_waitcnt lgkmcnt(5)
    v_mfma_f32_16x16x32_bf16 v[16:19], v[48:51], v[64:67], v[16:19]
    ds_read_b128 v[76:79], v4 offset:672
    v_mfma_f32_16x16x32_bf16 v[20:23], v[52:55], v[64:67], v[20:23]
    ds_read_b128 v[44:47], v3 offset:608
    v_mfma_f32_16x16x32_bf16 v[24:27], v[56:59], v[64:67], v[24:27]
    v_mfma_f32_16x16x32_bf16 v[28:31], v[60:63], v[64:67], v[28:31]
    s_add_u32 s81, s81, s24
    s_mul_i32 s82, s91, 640
    s_waitcnt lgkmcnt(5)
    v_mfma_f32_16x16x32_bf16 v[16:19], v[52:55], v[68:71], v[16:19]
    ds_read_b128 v[64:67], v4 offset:432
    v_mfma_f32_16x16x32_bf16 v[20:23], v[56:59], v[68:71], v[20:23]
    ds_read_b128 v[48:51], v3 offset:640
    v_mfma_f32_16x16x32_bf16 v[24:27], v[60:63], v[68:71], v[24:27]
    s_add_u32 s76, s76, 4096
    buffer_load_dwordx4 a[192:195], v2, s[32:35], s76 offen offset:0 sc1
    v_mfma_f32_16x16x32_bf16 v[28:31], v[32:35], v[68:71], v[28:31]
    s_waitcnt lgkmcnt(5)
    v_mfma_f32_16x16x32_bf16 v[16:19], v[56:59], v[72:75], v[16:19]
    ds_read_b128 v[68:71], v4 offset:464
    v_mfma_f32_16x16x32_bf16 v[20:23], v[60:63], v[72:75], v[20:23]
    ds_read_b128 v[52:55], v3 offset:672
    v_mfma_f32_16x16x32_bf16 v[24:27], v[32:35], v[72:75], v[24:27]
    buffer_load_dwordx4 a[196:199], v2, s[32:35], s76 offen offset:1024 sc1
    v_mfma_f32_16x16x32_bf16 v[28:31], v[36:39], v[72:75], v[28:31]
    s_cmp_eq_u32 s90, 2
    s_cselect_b32 s80, s87, s80
    s_cselect_b32 s81, s25, s81
    s_waitcnt lgkmcnt(5)
    v_mfma_f32_16x16x32_bf16 v[16:19], v[60:63], v[76:79], v[16:19]
    ds_read_b128 v[72:75], v4 offset:496
    v_mfma_f32_16x16x32_bf16 v[20:23], v[32:35], v[76:79], v[20:23]
    ds_read_b128 v[56:59], v3 offset:704
    v_mfma_f32_16x16x32_bf16 v[24:27], v[36:39], v[76:79], v[24:27]
    v_mfma_f32_16x16x32_bf16 v[28:31], v[40:43], v[76:79], v[28:31]
    s_waitcnt lgkmcnt(5)
    v_mfma_f32_16x16x32_bf16 v[16:19], v[32:35], v[64:67], v[16:19]
    ds_read_b128 v[76:79], v4 offset:528
    v_mfma_f32_16x16x32_bf16 v[20:23], v[36:39], v[64:67], v[20:23]
    ds_read_b128 v[60:63], v3 offset:736
    v_mfma_f32_16x16x32_bf16 v[24:27], v[40:43], v[64:67], v[24:27]
    buffer_load_dwordx4 a[200:203], v2, s[32:35], s76 offen offset:2048 sc1
    v_mfma_f32_16x16x32_bf16 v[28:31], v[44:47], v[64:67], v[28:31]
    s_add_u32 s81, s81, s82
    s_lshl_b32 s81, s81, 8
    s_waitcnt lgkmcnt(5)
    v_mfma_f32_16x16x32_bf16 v[16:19], v[36:39], v[68:71], v[16:19]
    ds_read_b128 v[64:67], v4 offset:288
    v_mfma_f32_16x16x32_bf16 v[20:23], v[40:43], v[68:71], v[20:23]
    ds_read_b128 v[32:35], v3 offset:768
    v_mfma_f32_16x16x32_bf16 v[24:27], v[44:47], v[68:71], v[24:27]
    v_mfma_f32_16x16x32_bf16 v[28:31], v[48:51], v[68:71], v[28:31]
    s_waitcnt lgkmcnt(5)
    v_mfma_f32_16x16x32_bf16 v[16:19], v[40:43], v[72:75], v[16:19]
    ds_read_b128 v[68:71], v4 offset:320
    v_mfma_f32_16x16x32_bf16 v[20:23], v[44:47], v[72:75], v[20:23]
    ds_read_b128 v[36:39], v3 offset:800
    v_mfma_f32_16x16x32_bf16 v[24:27], v[48:51], v[72:75], v[24:27]
    buffer_load_dwordx4 a[204:207], v2, s[32:35], s76 offen offset:3072 sc1
    v_mfma_f32_16x16x32_bf16 v[28:31], v[52:55], v[72:75], v[28:31]
    s_add_u32 s81, s81, 0x280000
    s_mov_b32 s82, 0xffff0000
    s_waitcnt lgkmcnt(5)
    v_mfma_f32_16x16x32_bf16 v[16:19], v[44:47], v[76:79], v[16:19]
    ds_read_b128 v[72:75], v4 offset:352
    v_mfma_f32_16x16x32_bf16 v[20:23], v[48:51], v[76:79], v[20:23]
    ds_read_b128 v[40:43], v3 offset:832
    v_mfma_f32_16x16x32_bf16 v[24:27], v[52:55], v[76:79], v[24:27]
    s_add_u32 s76, s76, 4096
    buffer_load_dwordx4 a[208:211], v2, s[32:35], s76 offen offset:0 sc1
    v_mfma_f32_16x16x32_bf16 v[28:31], v[56:59], v[76:79], v[28:31]
    s_waitcnt lgkmcnt(5)
    v_mfma_f32_16x16x32_bf16 v[16:19], v[48:51], v[64:67], v[16:19]
    ds_read_b128 v[76:79], v4 offset:384
    v_mfma_f32_16x16x32_bf16 v[20:23], v[52:55], v[64:67], v[20:23]
    ds_read_b128 v[44:47], v3 offset:864
    v_mfma_f32_16x16x32_bf16 v[24:27], v[56:59], v[64:67], v[24:27]
    v_mfma_f32_16x16x32_bf16 v[28:31], v[60:63], v[64:67], v[28:31]
    v_mov_b32 v145, s13
    v_mov_b32 v147, s13
    v_mov_b32 v149, s13
    s_waitcnt lgkmcnt(5)
    v_mfma_f32_16x16x32_bf16 v[16:19], v[52:55], v[68:71], v[16:19]
    ds_read_b128 v[64:67], v4 offset:144
    v_mfma_f32_16x16x32_bf16 v[20:23], v[56:59], v[68:71], v[20:23]
    ds_read_b128 v[48:51], v3 offset:896
    v_mfma_f32_16x16x32_bf16 v[24:27], v[60:63], v[68:71], v[24:27]
    buffer_load_dwordx4 a[212:215], v2, s[32:35], s76 offen offset:1024 sc1
    v_mfma_f32_16x16x32_bf16 v[28:31], v[32:35], v[68:71], v[28:31]
    s_waitcnt lgkmcnt(5)
    v_mfma_f32_16x16x32_bf16 v[16:19], v[56:59], v[72:75], v[16:19]
    ds_read_b128 v[68:71], v4 offset:176
    v_mfma_f32_16x16x32_bf16 v[20:23], v[60:63], v[72:75], v[20:23]
    ds_read_b128 v[52:55], v3 offset:928
    v_mfma_f32_16x16x32_bf16 v[24:27], v[32:35], v[72:75], v[24:27]
    v_mfma_f32_16x16x32_bf16 v[28:31], v[36:39], v[72:75], v[28:31]
    v_mov_b32 v151, s13
    v_mov_b32 v153, s13
    v_mov_b32 v155, s13
    s_waitcnt lgkmcnt(5)
    v_mfma_f32_16x16x32_bf16 v[16:19], v[60:63], v[76:79], v[16:19]
    ds_read_b128 v[72:75], v4 offset:208
    v_mfma_f32_16x16x32_bf16 v[20:23], v[32:35], v[76:79], v[20:23]
    ds_read_b128 v[56:59], v3 offset:960
    v_mfma_f32_16x16x32_bf16 v[24:27], v[36:39], v[76:79], v[24:27]
    buffer_load_dwordx4 a[216:219], v2, s[32:35], s76 offen offset:2048 sc1
    v_mfma_f32_16x16x32_bf16 v[28:31], v[40:43], v[76:79], v[28:31]
    s_waitcnt lgkmcnt(5)
    v_mfma_f32_16x16x32_bf16 v[16:19], v[32:35], v[64:67], v[16:19]
    ds_read_b128 v[76:79], v4 offset:240
    v_mfma_f32_16x16x32_bf16 v[20:23], v[36:39], v[64:67], v[20:23]
    ds_read_b128 v[60:63], v3 offset:992
    v_mfma_f32_16x16x32_bf16 v[24:27], v[40:43], v[64:67], v[24:27]
    buffer_load_dwordx4 a[220:223], v2, s[32:35], s76 offen offset:3072 sc1
    v_mfma_f32_16x16x32_bf16 v[28:31], v[44:47], v[64:67], v[28:31]
    v_mov_b32 v157, s13
    v_mov_b32 v159, s13
    s_waitcnt lgkmcnt(5)
    v_mfma_f32_16x16x32_bf16 v[16:19], v[36:39], v[68:71], v[16:19]
    ds_read_b128 v[64:67], v4 offset:0
    v_mfma_f32_16x16x32_bf16 v[20:23], v[40:43], v[68:71], v[20:23]
    ds_read_b128 v[32:35], v3 offset:1024
    v_mfma_f32_16x16x32_bf16 v[24:27], v[44:47], v[68:71], v[24:27]
    v_mfma_f32_16x16x32_bf16 v[28:31], v[48:51], v[68:71], v[28:31]
    s_waitcnt lgkmcnt(5)
    v_mfma_f32_16x16x32_bf16 v[16:19], v[40:43], v[72:75], v[16:19]
    ds_read_b128 v[68:71], v4 offset:32
    v_mfma_f32_16x16x32_bf16 v[20:23], v[44:47], v[72:75], v[20:23]
    ds_read_b128 v[36:39], v3 offset:1056
    v_mfma_f32_16x16x32_bf16 v[24:27], v[48:51], v[72:75], v[24:27]
    s_add_u32 s76, s76, 4096
    buffer_load_dwordx4 a[224:227], v2, s[32:35], s76 offen offset:0 sc1
    v_mfma_f32_16x16x32_bf16 v[28:31], v[52:55], v[72:75], v[28:31]
    ds_read_b64 v[84:85], v81 offset:96
    ds_read_b64 v[86:87], v81 offset:64
    ds_read_b64 v[88:89], v81 offset:32
    ds_read_b64 v[90:91], v81 offset:0
    s_waitcnt lgkmcnt(9)
    v_mfma_f32_16x16x32_bf16 v[16:19], v[44:47], v[76:79], v[16:19]
    ds_read_b128 v[72:75], v4 offset:64
    v_mfma_f32_16x16x32_bf16 v[20:23], v[48:51], v[76:79], v[20:23]
    ds_read_b128 v[40:43], v3 offset:1088
    v_mfma_f32_16x16x32_bf16 v[24:27], v[52:55], v[76:79], v[24:27]
    v_mfma_f32_16x16x32_bf16 v[28:31], v[56:59], v[76:79], v[28:31]
    s_waitcnt lgkmcnt(9)
    v_mfma_f32_16x16x32_bf16 v[16:19], v[48:51], v[64:67], v[16:19]
    ds_read_b128 v[76:79], v4 offset:96
    v_mfma_f32_16x16x32_bf16 v[20:23], v[52:55], v[64:67], v[20:23]
    v_mfma_f32_16x16x32_bf16 v[24:27], v[56:59], v[64:67], v[24:27]
    buffer_load_dwordx4 a[228:231], v2, s[32:35], s76 offen offset:1024 sc1
    v_mfma_f32_16x16x32_bf16 v[28:31], v[60:63], v[64:67], v[28:31]
    s_waitcnt lgkmcnt(8)
    v_mfma_f32_16x16x32_bf16 v[16:19], v[52:55], v[68:71], v[16:19]
    v_mfma_f32_16x16x32_bf16 v[20:23], v[56:59], v[68:71], v[20:23]
    v_mfma_f32_16x16x32_bf16 v[24:27], v[60:63], v[68:71], v[24:27]
    v_mfma_f32_16x16x32_bf16 v[28:31], v[32:35], v[68:71], v[28:31]
    s_waitcnt lgkmcnt(2)
    v_mfma_f32_16x16x32_bf16 v[16:19], v[56:59], v[72:75], v[16:19]
    v_mfma_f32_16x16x32_bf16 v[20:23], v[60:63], v[72:75], v[20:23]
    v_and_b32 v128, s82, v85
    v_lshlrev_b32 v129, 16, v85
    v_and_b32 v130, s82, v84
    v_mfma_f32_16x16x32_bf16 v[24:27], v[32:35], v[72:75], v[24:27]
    buffer_load_dwordx4 a[232:235], v2, s[32:35], s76 offen offset:2048 sc1
    v_lshlrev_b32 v131, 16, v84
    v_and_b32 v132, s82, v87
    v_lshlrev_b32 v133, 16, v87
    v_mfma_f32_16x16x32_bf16 v[28:31], v[36:39], v[72:75], v[28:31]
    v_and_b32 v134, s82, v86
    v_lshlrev_b32 v135, 16, v86
    v_and_b32 v136, s82, v89
    s_waitcnt lgkmcnt(0)
    v_mfma_f32_16x16x32_bf16 v[16:19], v[60:63], v[76:79], v[16:19]
    v_mfma_f32_16x16x32_bf16 v[20:23], v[32:35], v[76:79], v[20:23]
    v_lshlrev_b32 v137, 16, v89
    v_and_b32 v138, s82, v88
    v_lshlrev_b32 v139, 16, v88
    v_mfma_f32_16x16x32_bf16 v[24:27], v[36:39], v[76:79], v[24:27]
    buffer_load_dwordx4 a[236:239], v2, s[32:35], s76 offen offset:3072 sc1
    v_and_b32 v140, s82, v91
    v_lshlrev_b32 v141, 16, v91
    v_and_b32 v142, s82, v90
    v_mfma_f32_16x16x32_bf16 v[28:31], v[40:43], v[76:79], v[28:31]
    v_lshlrev_b32 v143, 16, v90
    v_fmac_f32 v16, s80, v128
    v_fmac_f32 v17, s80, v129
    v_fmac_f32 v18, s80, v130
    v_fmac_f32 v19, s80, v131
    v_cvt_pk_bf16_f32 v92, v16, v17
    v_cvt_pk_bf16_f32 v93, v18, v19
    ds_write_b64 v118, v[92:93] offset:0
    v_fmac_f32 v20, s80, v132
    v_fmac_f32 v21, s80, v133
    v_fmac_f32 v22, s80, v134
    v_fmac_f32 v23, s80, v135
    v_cvt_pk_bf16_f32 v94, v20, v21
    v_cvt_pk_bf16_f32 v95, v22, v23
    ds_write_b64 v118, v[94:95] offset:32
    v_fmac_f32 v24, s80, v136
    v_fmac_f32 v25, s80, v137
    v_fmac_f32 v26, s80, v138
    v_fmac_f32 v27, s80, v139
    v_cvt_pk_bf16_f32 v96, v24, v25
    v_cvt_pk_bf16_f32 v97, v26, v27
    ds_write_b64 v118, v[96:97] offset:64
    v_fmac_f32 v28, s80, v140
    v_fmac_f32 v29, s80, v141
    v_fmac_f32 v30, s80, v142
    v_fmac_f32 v31, s80, v143
    v_cvt_pk_bf16_f32 v98, v28, v29
    v_cvt_pk_bf16_f32 v99, v30, v31
    ds_write_b64 v118, v[98:99] offset:96
    s_waitcnt lgkmcnt(0)
    ds_read_b32 v144, v119 offset:0
    ds_read_b32 v146, v119 offset:4
    ds_read_b32 v148, v119 offset:544
    ds_read_b32 v150, v119 offset:548
    ds_read_b32 v152, v119 offset:1088
    ds_read_b32 v154, v119 offset:1092
    ds_read_b32 v156, v119 offset:1632
    ds_read_b32 v158, v119 offset:1636
    s_waitcnt lgkmcnt(6)
    buffer_store_dwordx4 v[144:147], v120, s[32:35], s81 offen sc1
    s_add_u32 s81, s81, 655360
    s_waitcnt lgkmcnt(4)
    buffer_store_dwordx4 v[148:151], v120, s[32:35], s81 offen sc1
    s_add_u32 s81, s81, 655360
    s_waitcnt lgkmcnt(2)
    buffer_store_dwordx4 v[152:155], v120, s[32:35], s81 offen sc1
    s_add_u32 s81, s81, 655360
    s_waitcnt lgkmcnt(0)
    buffer_store_dwordx4 v[156:159], v120, s[32:35], s81 offen sc1
L_p1_done:
    s_and_b32 s95, s7, 1
    s_lshl_b32 s95, s95, 3
    s_mul_i32 s47, s5, 35840
    s_waitcnt vmcnt(23)
    ds_read_b64 v[192:193], v127 offset:0
    ds_read_b64 v[194:195], v127 offset:8
    ds_read_b64 v[196:197], v127 offset:16
    ds_read_b64 v[198:199], v127 offset:24
    ds_read_b64 v[200:201], v127 offset:32
    ds_read_b32 v5, v5
    s_waitcnt lgkmcnt(0)
    v_readfirstlane_b32 s11, v5
    s_barrier
    s_add_u32 s76, s76, 4096
    s_add_u32 m0, s47, 32768
    s_nop 0
    buffer_load_dwordx4 v2, s[32:35], s76 offen offset:0 sc1 lds
    s_add_u32 m0, s47, 32768
    s_nop 0
    buffer_load_dwordx4 v2, s[32:35], s76 offen offset:1024 sc1 lds
    s_add_u32 m0, s47, 32768
    s_nop 0
    buffer_load_dwordx4 v2, s[32:35], s76 offen offset:2048 sc1 lds
    buffer_load_dwordx4 a[0:3], v2, s[32:35], s73 offen offset:0 sc1
    buffer_load_dwordx4 a[4:7], v2, s[32:35], s73 offen offset:1024 sc1
    buffer_load_dwordx4 a[8:11], v2, s[32:35], s73 offen offset:2048 sc1
    buffer_load_dwordx4 a[12:15], v2, s[32:35], s73 offen offset:3072 sc1
    s_add_u32 s73, s73, 4096
    buffer_load_dwordx4 a[16:19], v2, s[32:35], s73 offen offset:0 sc1
    buffer_load_dwordx4 a[20:23], v2, s[32:35], s73 offen offset:1024 sc1
    buffer_load_dwordx4 a[24:27], v2, s[32:35], s73 offen offset:2048 sc1
    buffer_load_dwordx4 a[28:31], v2, s[32:35], s73 offen offset:3072 sc1
    s_add_u32 s73, s73, 4096
    buffer_load_dwordx4 a[32:35], v2, s[32:35], s73 offen offset:0 sc1
    buffer_load_dwordx4 a[36:39], v2, s[32:35], s73 offen offset:1024 sc1
    s_lshl_b32 s96, s3, 1
    s_add_u32 s96, s96, s6
    s_lshl_b32 s96, s96, 2
    s_add_u32 s96, s96, s5
    s_lshr_b32 s14, s96, 1
    s_mul_i32 s14, s14, 163840
    s_add_u32 s14, s14, 0x280000
    s_and_b32 s100, s96, 1
    s_lshl_b32 s101, s100, 11
    s_add_u32 s22, s14, s101
    s_add_u32 s22, s22, 8192
    s_lshl_b32 s100, s100, 12
    s_add_u32 s14, s14, s100
    s_mov_b32 s88, s48
    s_mov_b32 s89, s49
    s_mov_b32 s90, s50
    s_mov_b32 s91, s51
    s_lshr_b32 s96, s27, 6
    s_mul_i32 s96, s96, 163840
    s_add_u32 s96, s96, 0x280000
    s_lshl_b32 s100, s5, 10
    s_add_u32 s80, s96, s100
    s_add_u32 s80, s80, 12288
    s_mul_i32 s101, s9, 20480
    s_add_u32 s81, s80, s101
    s_add_u32 s82, s96, s101
    s_lshl_b32 s101, s5, 11
    s_add_u32 s82, s82, s101
    s_and_b32 s101, s9, 6
    s_mul_i32 s101, s101, 20480
    s_add_u32 s83, s96, s101
    s_add_u32 s83, s83, s100
    s_and_b32 s101, s9, 1
    s_lshl_b32 s101, s101, 3
    s_add_u32 s83, s83, s101
    s_add_u32 s83, s83, 8192
    s_xor_b32 s66, s13, 0x5bd1e995
    s_lshl_b32 s96, s8, 2
    s_add_u32 s96, s96, s5
    s_lshl_b32 s96, s96, 3
    s_add_u32 s96, s96, s9
    s_lshl_b32 s96, s96, 2
    s_add_u32 s84, s96, s26
    s_add_u32 s84, s84, 1024
    s_lshl_b32 s96, s6, 2
    s_add_u32 s96, s96, s5
    s_lshl_b32 s96, s96, 6
    s_add_u32 s85, s96, s26
    s_lshl_b32 s100, s7, 2
    s_add_u32 s86, s85, s100
    s_add_u32 s86, s86, 2048
    s_lshl_b32 s96, s8, 7
    s_lshl_b32 s100, s5, 4
    s_add_u32 s96, s96, s100
    s_add_u32 s87, s96, s26
    s_mul_i32 s92, s7, 216
    s_mov_b32 s28, 0x3acccccd
    s_mov_b32 s29, 0x3727c5ac
    s_mov_b32 s30, 0x3fb8aa3b
    s_mov_b32 s72, 0x3f317218
    s_mov_b32 s93, 0xffff0000
    s_lshl_b32 s100, s3, 2
    s_add_u32 s100, s100, s8
    s_mul_i32 s101, s100, 229376
    s_mul_i32 s96, s5, 14336
    s_add_u32 s101, s101, s96
    s_add_u32 s101, s101, 0xa00000
    s_add_u32 s15, s14, 20480
    s_add_u32 s16, s14, 40960
    s_add_u32 s17, s14, 61440
    s_add_u32 s18, s14, 81920
    s_add_u32 s19, s14, 102400
    s_add_u32 s20, s14, 122880
    s_add_u32 s21, s14, 143360
    s_add_u32 s23, s22, 40960
    s_add_u32 s64, s22, 81920
    s_add_u32 s65, s22, 122880
    s_add_u32 s67, s80, 0
    s_add_u32 s68, s80, 20480
    s_add_u32 s69, s80, 40960
    s_add_u32 s70, s80, 61440
    s_add_u32 s71, s80, 81920
    s_add_u32 s44, s80, 102400
    s_add_u32 s45, s80, 122880
    s_add_u32 s46, s80, 143360
    s_add_u32 s96, s5, 1
    s_and_b32 s96, s96, 3
    s_mul_i32 s48, s96, 57344
    s_add_u32 s48, s48, s101
    s_add_u32 s49, s48, 4096
    s_add_u32 s50, s48, 8192
    s_add_u32 s51, s48, 12288
    s_add_u32 s96, s5, 0
    s_and_b32 s96, s96, 3
    s_mul_i32 s96, s96, 5120
    s_add_u32 s96, s96, 143360
    v_add_u32 v8, s96, v2
    s_add_u32 s96, s5, 2
    s_and_b32 s96, s96, 3
    s_mul_i32 s52, s96, 57344
    s_add_u32 s52, s52, s101
    s_add_u32 s53, s52, 4096
    s_add_u32 s54, s52, 8192
    s_add_u32 s55, s52, 12288
    s_add_u32 s96, s5, 3
    s_and_b32 s96, s96, 3
    s_mul_i32 s96, s96, 5120
    s_add_u32 s96, s96, 143360
    v_add_u32 v9, s96, v2
    s_add_u32 s96, s5, 3
    s_and_b32 s96, s96, 3
    s_mul_i32 s56, s96, 57344
    s_add_u32 s56, s56, s101
    s_add_u32 s57, s56, 4096
    s_add_u32 s58, s56, 8192
    s_add_u32 s59, s56, 12288
    s_add_u32 s96, s5, 1
    s_and_b32 s96, s96, 3
    s_mul_i32 s96, s96, 5120
    s_add_u32 s96, s96, 143360
    v_add_u32 v10, s96, v2
    s_add_u32 s96, s5, 4
    s_and_b32 s96, s96, 3
    s_mul_i32 s60, s96, 57344
    s_add_u32 s60, s60, s101
    s_add_u32 s61, s60, 4096
    s_add_u32 s62, s60, 8192
    s_add_u32 s63, s60, 12288
    s_add_u32 s96, s5, 2
    s_and_b32 s96, s96, 3
    s_mul_i32 s96, s96, 5120
    s_add_u32 s96, s96, 143360
    v_add_u32 v11, s96, v2
    v_lshrrev_b32 v20, 4, v1
    v_bfe_u32 v21, v1, 2, 2
    v_and_b32 v22, 3, v1
    v_add_u32 v4, 64512, v2
    v_add_u32 v5, 129024, v2
    v_and_b32 v6, 15, v1
    v_lshlrev_b32 v6, 2, v6
    v_bfe_u32 v7, v1, 2, 1
    v_lshlrev_b32 v7, 6, v7
    v_lshl_add_u32 v7, v22, 2, v7
    v_lshlrev_b32 v189, 3, v20
    s_mul_i32 s100, s100, 163840
    s_mul_i32 s96, s9, 20480
    s_add_u32 s100, s100, s96
    s_mul_i32 s96, s5, 5120
    s_add_u32 s100, s100, s96
    s_add_u32 s100, s100, 0x280000
    s_add_u32 s101, s100, 4096
    v_mul_u32_u24 v17, 160, v20
    v_and_b32 v18, 15, v1
    v_lshl_add_u32 v17, v18, 3, v17
    s_mul_i32 s96, s5, 3200
    s_add_u32 s96, s96, 143360
    v_add_u32 v17, s96, v17
    v_add_u32 v18, 1280, v17
    v_add_u32 v23, 2560, v17
    v_mul_u32_u24 v19, 20, v20
    v_add_u32 v19, v19, v21
    v_mul_u32_u24 v19, 160, v19
    v_lshl_add_u32 v19, v22, 3, v19
    s_lshl_b32 s96, s5, 5
    s_add_u32 s96, s96, 143360
    v_add_u32 v19, s96, v19
    v_lshlrev_b32 v212, 16, v192
    v_and_b32 v213, s93, v192
    v_lshlrev_b32 v214, 16, v193
    v_and_b32 v215, s93, v193
    v_lshlrev_b32 v216, 16, v194
    v_and_b32 v217, s93, v194
    v_lshlrev_b32 v218, 16, v195
    v_and_b32 v219, s93, v195
    v_lshlrev_b32 v220, 16, v196
    v_and_b32 v221, s93, v196
    v_lshlrev_b32 v222, 16, v197
    v_and_b32 v223, s93, v197
    v_lshlrev_b32 v224, 16, v198
    v_and_b32 v225, s93, v198
    v_lshlrev_b32 v226, 16, v199
    v_and_b32 v227, s93, v199
    v_lshlrev_b32 v228, 16, v200
    v_and_b32 v229, s93, v200
    v_lshlrev_b32 v230, 16, v201
    v_and_b32 v231, s93, v201
    buffer_load_dwordx4 v[24:27], v2, s[32:35], s100 offen offset:0 sc1
    buffer_load_dwordx4 v[28:31], v2, s[32:35], s100 offen offset:1024 sc1
    buffer_load_dwordx4 v[32:35], v2, s[32:35], s100 offen offset:2048 sc1
    buffer_load_dwordx4 v[36:39], v2, s[32:35], s100 offen offset:3072 sc1
    buffer_load_dwordx4 v[40:43], v2, s[32:35], s101 offen offset:0 sc1
    s_waitcnt vmcnt(50)
    ds_write_b128 v188, a[112:115] offset:0
    ds_write_b128 v188, a[116:119] offset:1024
    ds_write_b128 v188, a[120:123] offset:2048
    ds_write_b128 v188, a[124:127] offset:3072
    s_waitcnt vmcnt(46)
    ds_write_b128 v188, a[128:131] offset:4096
    ds_write_b128 v188, a[132:135] offset:5120
    ds_write_b128 v188, a[136:139] offset:6144
    ds_write_b128 v188, a[140:143] offset:7168
    s_waitcnt vmcnt(42)
    ds_write_b128 v188, a[144:147] offset:8192
    ds_write_b128 v188, a[148:151] offset:9216
    ds_write_b128 v188, a[152:155] offset:10240
    ds_write_b128 v188, a[156:159] offset:11264
    s_waitcnt vmcnt(38)
    ds_write_b128 v188, a[160:163] offset:12288
    ds_write_b128 v188, a[164:167] offset:13312
    ds_write_b128 v188, a[168:171] offset:14336
    ds_write_b128 v188, a[172:175] offset:15360
    s_mov_b32 s97, 0
poll_18:
    s_waitcnt vmcnt(0)
    v_xor_b32 v44, s13, v25
    v_bitop3_b32 v44, v27, s13, v44 bitop3:0xbe
    v_bitop3_b32 v44, v29, s13, v44 bitop3:0xbe
    v_bitop3_b32 v44, v31, s13, v44 bitop3:0xbe
    v_bitop3_b32 v44, v33, s13, v44 bitop3:0xbe
    v_bitop3_b32 v44, v35, s13, v44 bitop3:0xbe
    v_bitop3_b32 v44, v37, s13, v44 bitop3:0xbe
    v_bitop3_b32 v44, v39, s13, v44 bitop3:0xbe
    v_bitop3_b32 v44, v41, s13, v44 bitop3:0xbe
    v_bitop3_b32 v44, v43, s13, v44 bitop3:0xbe
    v_cmp_ne_u32 vcc, 0, v44
    s_cbranch_vccnz pretry_20
pdone_19:
    ds_write2_b32 v17, v24, v26 offset0:0 offset1:1
    ds_write2_b32 v17, v28, v30 offset0:160 offset1:161
    ds_write2_b32 v18, v32, v34 offset0:0 offset1:1
    ds_write2_b32 v18, v36, v38 offset0:160 offset1:161
    ds_write2_b32 v23, v40, v42 offset0:0 offset1:1
    s_waitcnt lgkmcnt(5)
    buffer_load_dwordx4 a[40:43], v2, s[32:35], s73 offen offset:2048 sc1
    buffer_load_dwordx4 a[44:47], v2, s[32:35], s73 offen offset:3072 sc1
    s_add_u32 s73, s73, 4096
    buffer_load_dwordx4 a[48:51], v2, s[32:35], s73 offen offset:0 sc1
    buffer_load_dwordx4 a[52:55], v2, s[32:35], s73 offen offset:1024 sc1
    buffer_load_dwordx4 a[56:59], v2, s[32:35], s73 offen offset:2048 sc1
    buffer_load_dwordx4 a[60:63], v2, s[32:35], s73 offen offset:3072 sc1
    s_add_u32 s73, s73, 4096
    buffer_load_dwordx4 a[64:67], v2, s[32:35], s73 offen offset:0 sc1
    buffer_load_dwordx4 a[68:71], v2, s[32:35], s73 offen offset:1024 sc1
    s_waitcnt lgkmcnt(0)
    s_barrier
    ds_read_b64_tr_b16 v[24:25], v19 offset:0
    ds_read_b64_tr_b16 v[26:27], v19 offset:640
    ds_read_b64_tr_b16 v[28:29], v19 offset:1280
    ds_read_b64_tr_b16 v[30:31], v19 offset:1920
    ds_read_b64_tr_b16 v[32:33], v19 offset:2560
    s_waitcnt lgkmcnt(4)
    v_lshlrev_b32 v192, 16, v24
    v_and_b32 v193, s93, v24
    v_lshlrev_b32 v194, 16, v25
    v_and_b32 v195, s93, v25
    s_waitcnt lgkmcnt(3)
    v_lshlrev_b32 v196, 16, v26
    v_and_b32 v197, s93, v26
    v_lshlrev_b32 v198, 16, v27
    v_and_b32 v199, s93, v27
    s_waitcnt lgkmcnt(2)
    v_lshlrev_b32 v200, 16, v28
    v_and_b32 v201, s93, v28
    v_lshlrev_b32 v202, 16, v29
    v_and_b32 v203, s93, v29
    s_waitcnt lgkmcnt(1)
    v_lshlrev_b32 v204, 16, v30
    v_and_b32 v205, s93, v30
    v_lshlrev_b32 v206, 16, v31
    v_and_b32 v207, s93, v31
    s_waitcnt lgkmcnt(0)
    v_lshlrev_b32 v208, 16, v32
    v_and_b32 v209, s93, v32
    v_lshlrev_b32 v210, 16, v33
    v_and_b32 v211, s93, v33
    v_pk_add_f32 v[24:25], v[192:193], v[194:195]
    v_pk_mul_f32 v[26:27], v[192:193], v[192:193]
    v_pk_fma_f32 v[26:27], v[194:195], v[194:195], v[26:27]
    v_pk_add_f32 v[24:25], v[24:25], v[196:197]
    v_pk_fma_f32 v[26:27], v[196:197], v[196:197], v[26:27]
    v_pk_add_f32 v[24:25], v[24:25], v[198:199]
    v_pk_fma_f32 v[26:27], v[198:199], v[198:199], v[26:27]
    v_pk_add_f32 v[24:25], v[24:25], v[200:201]
    v_pk_fma_f32 v[26:27], v[200:201], v[200:201], v[26:27]
    v_pk_add_f32 v[24:25], v[24:25], v[202:203]
    v_pk_fma_f32 v[26:27], v[202:203], v[202:203], v[26:27]
    v_pk_add_f32 v[24:25], v[24:25], v[204:205]
    v_pk_fma_f32 v[26:27], v[204:205], v[204:205], v[26:27]
    v_pk_add_f32 v[24:25], v[24:25], v[206:207]
    v_pk_fma_f32 v[26:27], v[206:207], v[206:207], v[26:27]
    v_pk_add_f32 v[24:25], v[24:25], v[208:209]
    v_pk_fma_f32 v[26:27], v[208:209], v[208:209], v[26:27]
    v_pk_add_f32 v[24:25], v[24:25], v[210:211]
    v_pk_fma_f32 v[26:27], v[210:211], v[210:211], v[26:27]
    v_add_f32 v12, v24, v25
    v_add_f32 v13, v26, v27
L_layer:
    v_pk_mul_f32 v[28:29], v[212:213], v[192:193]
    v_pk_mul_f32 v[18:19], v[212:213], v[212:213]
    v_pk_mul_f32 v[22:23], v[212:213], v[28:29]
    v_pk_mul_f32 v[24:25], v[28:29], v[28:29]
    v_pk_mul_f32 v[26:27], v[28:29], v[192:193]
    v_pk_mul_f32 v[30:31], v[214:215], v[194:195]
    v_pk_add_f32 v[16:17], v[212:213], v[214:215]
    v_pk_add_f32 v[20:21], v[28:29], v[30:31]
    v_pk_fma_f32 v[18:19], v[214:215], v[214:215], v[18:19]
    v_pk_fma_f32 v[22:23], v[214:215], v[30:31], v[22:23]
    v_pk_fma_f32 v[24:25], v[30:31], v[30:31], v[24:25]
    v_pk_fma_f32 v[26:27], v[30:31], v[194:195], v[26:27]
    v_pk_mul_f32 v[28:29], v[216:217], v[196:197]
    v_pk_add_f32 v[16:17], v[16:17], v[216:217]
    v_pk_add_f32 v[20:21], v[20:21], v[28:29]
    v_pk_fma_f32 v[18:19], v[216:217], v[216:217], v[18:19]
    v_pk_fma_f32 v[22:23], v[216:217], v[28:29], v[22:23]
    v_pk_fma_f32 v[24:25], v[28:29], v[28:29], v[24:25]
    v_pk_fma_f32 v[26:27], v[28:29], v[196:197], v[26:27]
    v_pk_mul_f32 v[30:31], v[218:219], v[198:199]
    v_pk_add_f32 v[16:17], v[16:17], v[218:219]
    v_pk_add_f32 v[20:21], v[20:21], v[30:31]
    v_pk_fma_f32 v[18:19], v[218:219], v[218:219], v[18:19]
    v_pk_fma_f32 v[22:23], v[218:219], v[30:31], v[22:23]
    v_pk_fma_f32 v[24:25], v[30:31], v[30:31], v[24:25]
    v_pk_fma_f32 v[26:27], v[30:31], v[198:199], v[26:27]
    v_pk_mul_f32 v[28:29], v[220:221], v[200:201]
    v_pk_add_f32 v[16:17], v[16:17], v[220:221]
    v_pk_add_f32 v[20:21], v[20:21], v[28:29]
    v_pk_fma_f32 v[18:19], v[220:221], v[220:221], v[18:19]
    v_pk_fma_f32 v[22:23], v[220:221], v[28:29], v[22:23]
    v_pk_fma_f32 v[24:25], v[28:29], v[28:29], v[24:25]
    v_pk_fma_f32 v[26:27], v[28:29], v[200:201], v[26:27]
    v_pk_mul_f32 v[30:31], v[222:223], v[202:203]
    v_pk_add_f32 v[16:17], v[16:17], v[222:223]
    v_pk_add_f32 v[20:21], v[20:21], v[30:31]
    v_pk_fma_f32 v[18:19], v[222:223], v[222:223], v[18:19]
    v_pk_fma_f32 v[22:23], v[222:223], v[30:31], v[22:23]
    v_pk_fma_f32 v[24:25], v[30:31], v[30:31], v[24:25]
    v_pk_fma_f32 v[26:27], v[30:31], v[202:203], v[26:27]
    v_pk_mul_f32 v[28:29], v[224:225], v[204:205]
    v_pk_add_f32 v[16:17], v[16:17], v[224:225]
    v_pk_add_f32 v[20:21], v[20:21], v[28:29]
    v_pk_fma_f32 v[18:19], v[224:225], v[224:225], v[18:19]
    v_pk_fma_f32 v[22:23], v[224:225], v[28:29], v[22:23]
    v_pk_fma_f32 v[24:25], v[28:29], v[28:29], v[24:25]
    v_pk_fma_f32 v[26:27], v[28:29], v[204:205], v[26:27]
    v_pk_mul_f32 v[30:31], v[226:227], v[206:207]
    v_pk_add_f32 v[16:17], v[16:17], v[226:227]
    v_pk_add_f32 v[20:21], v[20:21], v[30:31]
    v_pk_fma_f32 v[18:19], v[226:227], v[226:227], v[18:19]
    v_pk_fma_f32 v[22:23], v[226:227], v[30:31], v[22:23]
    v_pk_fma_f32 v[24:25], v[30:31], v[30:31], v[24:25]
    v_pk_fma_f32 v[26:27], v[30:31], v[206:207], v[26:27]
    v_pk_mul_f32 v[28:29], v[228:229], v[208:209]
    v_pk_add_f32 v[16:17], v[16:17], v[228:229]
    v_pk_add_f32 v[20:21], v[20:21], v[28:29]
    v_pk_fma_f32 v[18:19], v[228:229], v[228:229], v[18:19]
    v_pk_fma_f32 v[22:23], v[228:229], v[28:29], v[22:23]
    v_pk_fma_f32 v[24:25], v[28:29], v[28:29], v[24:25]
    v_pk_fma_f32 v[26:27], v[28:29], v[208:209], v[26:27]
    v_pk_mul_f32 v[30:31], v[230:231], v[210:211]
    v_pk_add_f32 v[16:17], v[16:17], v[230:231]
    v_pk_add_f32 v[20:21], v[20:21], v[30:31]
    v_pk_fma_f32 v[18:19], v[230:231], v[230:231], v[18:19]
    v_pk_fma_f32 v[22:23], v[230:231], v[30:31], v[22:23]
    v_pk_fma_f32 v[24:25], v[30:31], v[30:31], v[24:25]
    v_pk_fma_f32 v[26:27], v[30:31], v[210:211], v[26:27]
    v_mov_b32 v34, v12
    v_mov_b32 v39, v13
    v_add_f32 v32, v16, v17
    v_add_f32 v33, v18, v19
    v_add_f32 v35, v20, v21
    v_add_f32 v36, v22, v23
    v_add_f32 v37, v24, v25
    v_add_f32 v38, v26, v27
    v_mov_b32 v45, s66
    v_mov_b32 v47, s66
    v_permlane32_swap_b32 v32, v33
    v_permlane32_swap_b32 v34, v35
    v_permlane32_swap_b32 v36, v37
    v_permlane32_swap_b32 v38, v39
    v_add_f32 v40, v32, v33
    v_add_f32 v41, v34, v35
    v_add_f32 v42, v36, v37
    v_add_f32 v43, v38, v39
    s_nop 0
    v_mov_b32 v16, v2
    v_permlane16_swap_b32 v40, v41
    v_permlane16_swap_b32 v42, v43
    v_add_f32 v44, v40, v41
    v_add_f32 v46, v42, v43
    s_cmp_lg_u32 s11, 0
    s_cbranch_scc1 L_exs
    buffer_store_dwordx4 v[44:47], v16, s[32:35], s81 offen
L_exd:
    buffer_load_dwordx4 v[48:51], v16, s[32:35], s67 offen sc1
    buffer_load_dwordx4 v[52:55], v16, s[32:35], s68 offen sc1
    buffer_load_dwordx4 v[56:59], v16, s[32:35], s69 offen sc1
    buffer_load_dwordx4 v[60:63], v16, s[32:35], s70 offen sc1
    buffer_load_dwordx4 v[64:67], v16, s[32:35], s71 offen sc1
    buffer_load_dwordx4 v[68:71], v16, s[32:35], s44 offen sc1
    buffer_load_dwordx4 v[72:75], v16, s[32:35], s45 offen sc1
    buffer_load_dwordx4 v[76:79], v16, s[32:35], s46 offen sc1
    s_cmp_eq_u32 s10, 0
    s_cbranch_scc1 ool_26
back_27:
    s_mov_b32 s97, 0
poll_22:
    s_waitcnt vmcnt(0)
    v_xor_b32 v80, s66, v49
    v_bitop3_b32 v80, v51, s66, v80 bitop3:0xbe
    v_bitop3_b32 v80, v53, s66, v80 bitop3:0xbe
    v_bitop3_b32 v80, v55, s66, v80 bitop3:0xbe
    v_bitop3_b32 v80, v57, s66, v80 bitop3:0xbe
    v_bitop3_b32 v80, v59, s66, v80 bitop3:0xbe
    v_bitop3_b32 v80, v61, s66, v80 bitop3:0xbe
    v_bitop3_b32 v80, v63, s66, v80 bitop3:0xbe
    v_bitop3_b32 v80, v65, s66, v80 bitop3:0xbe
    v_bitop3_b32 v80, v67, s66, v80 bitop3:0xbe
    v_bitop3_b32 v80, v69, s66, v80 bitop3:0xbe
    v_bitop3_b32 v80, v71, s66, v80 bitop3:0xbe
    v_bitop3_b32 v80, v73, s66, v80 bitop3:0xbe
    v_bitop3_b32 v80, v75, s66, v80 bitop3:0xbe
    v_bitop3_b32 v80, v77, s66, v80 bitop3:0xbe
    v_bitop3_b32 v80, v79, s66, v80 bitop3:0xbe
    v_cmp_ne_u32 vcc, 0, v80
    s_cbranch_vccnz pretry_24
pdone_23:
    buffer_load_dwordx2 v[84:85], v189, s[40:43], s92 offen offset:0
    buffer_load_dwordx2 v[86:87], v189, s[40:43], s92 offen offset:32
    buffer_load_dwordx2 v[88:89], v189, s[40:43], s92 offen offset:64
    buffer_load_dwordx2 v[90:91], v189, s[40:43], s92 offen offset:96
    buffer_load_dwordx2 v[92:93], v189, s[40:43], s92 offen offset:128
    buffer_load_dwordx2 v[94:95], v189, s[40:43], s92 offen offset:160
    buffer_load_dwordx2 v[96:97], v189, s[40:43], s92 offen offset:192
    s_cmp_eq_u32 s10, 0
    s_cbranch_scc1 ool_28
back_29:
    v_add_f32 v48, v48, v52
    v_add_f32 v50, v50, v54
    v_add_f32 v56, v56, v60
    v_add_f32 v58, v58, v62
    v_add_f32 v64, v64, v68
    v_add_f32 v66, v66, v70
    v_add_f32 v72, v72, v76
    v_add_f32 v74, v74, v78
    v_add_f32 v48, v48, v56
    v_add_f32 v64, v64, v72
    v_add_f32 v50, v50, v58
    v_add_f32 v66, v66, v74
    v_add_f32 v32, v48, v64
    v_add_f32 v33, v50, v66
    v_add_f32 v34, v48, v64
    v_add_f32 v35, v50, v66
    s_nop 0
    v_permlane16_swap_b32 v32, v34
    v_permlane16_swap_b32 v33, v35
    v_mov_b32 v36, v32
    v_mov_b32 v37, v34
    v_mov_b32 v38, v33
    v_mov_b32 v39, v35
    v_permlane32_swap_b32 v32, v36
    v_permlane32_swap_b32 v34, v37
    v_permlane32_swap_b32 v33, v38
    v_permlane32_swap_b32 v35, v39
    v_mul_f32 v40, s28, v32
    v_mul_f32 v41, s28, v36
    v_fma_f32 v41, -v40, v40, v41
    v_max_f32 v41, 0, v41
    v_add_f32 v41, s29, v41
    v_rsq_f32 v42, v41
    v_fma_f32 v43, -v40, v34, v37
    v_fma_f32 v44, -v40, v37, v33
    v_mul_f32 v45, v40, v39
    v_fma_f32 v45, -2.0, v35, v45
    v_fma_f32 v45, v40, v45, v38
    v_fma_f32 v43, v42, v43, v32
    v_mul_f32 v45, v42, v45
    v_fma_f32 v45, 2.0, v44, v45
    v_fma_f32 v45, v42, v45, v36
    v_mul_f32 v43, s28, v43
    v_mul_f32 v45, s28, v45
    v_fma_f32 v45, -v43, v43, v45
    v_max_f32 v45, 0, v45
    v_add_f32 v45, s29, v45
    v_rsq_f32 v44, v45
    v_pk_mul_f32 v[48:49], v[192:193], v[42:43] op_sel_hi:[1,0]
    v_mul_f32 v44, s30, v44
    v_mul_f32 v46, v43, v44
    v_pk_add_f32 v[50:51], v[212:213], v[40:41] op_sel_hi:[1,0] neg_lo:[0,1] neg_hi:[0,1]
    v_pk_fma_f32 v[212:213], v[50:51], v[48:49], v[212:213]
    v_pk_fma_f32 v[50:51], v[212:213], v[44:45], v[46:47] op_sel_hi:[1,0,0] neg_lo:[0,0,1] neg_hi:[0,0,1]
    v_cvt_pk_bf16_f32 v72, v50, v51
    v_pk_mul_f32 v[52:53], v[194:195], v[42:43] op_sel_hi:[1,0]
    v_pk_add_f32 v[54:55], v[214:215], v[40:41] op_sel_hi:[1,0] neg_lo:[0,1] neg_hi:[0,1]
    v_pk_fma_f32 v[214:215], v[54:55], v[52:53], v[214:215]
    v_pk_fma_f32 v[54:55], v[214:215], v[44:45], v[46:47] op_sel_hi:[1,0,0] neg_lo:[0,0,1] neg_hi:[0,0,1]
    v_cvt_pk_bf16_f32 v73, v54, v55
    v_pk_mul_f32 v[48:49], v[196:197], v[42:43] op_sel_hi:[1,0]
    v_pk_add_f32 v[50:51], v[216:217], v[40:41] op_sel_hi:[1,0] neg_lo:[0,1] neg_hi:[0,1]
    v_pk_fma_f32 v[216:217], v[50:51], v[48:49], v[216:217]
    v_pk_fma_f32 v[50:51], v[216:217], v[44:45], v[46:47] op_sel_hi:[1,0,0] neg_lo:[0,0,1] neg_hi:[0,0,1]
    v_cvt_pk_bf16_f32 v74, v50, v51
    v_pk_mul_f32 v[52:53], v[198:199], v[42:43] op_sel_hi:[1,0]
    v_pk_add_f32 v[54:55], v[218:219], v[40:41] op_sel_hi:[1,0] neg_lo:[0,1] neg_hi:[0,1]
    v_pk_fma_f32 v[218:219], v[54:55], v[52:53], v[218:219]
    v_pk_fma_f32 v[54:55], v[218:219], v[44:45], v[46:47] op_sel_hi:[1,0,0] neg_lo:[0,0,1] neg_hi:[0,0,1]
    v_cvt_pk_bf16_f32 v75, v54, v55
    buffer_store_dwordx4 v[72:75], v2, s[32:35], s82 offen
    v_pk_mul_f32 v[48:49], v[200:201], v[42:43] op_sel_hi:[1,0]
    v_pk_add_f32 v[50:51], v[220:221], v[40:41] op_sel_hi:[1,0] neg_lo:[0,1] neg_hi:[0,1]
    v_pk_fma_f32 v[220:221], v[50:51], v[48:49], v[220:221]
    v_pk_fma_f32 v[50:51], v[220:221], v[44:45], v[46:47] op_sel_hi:[1,0,0] neg_lo:[0,0,1] neg_hi:[0,0,1]
    v_cvt_pk_bf16_f32 v76, v50, v51
    v_pk_mul_f32 v[52:53], v[202:203], v[42:43] op_sel_hi:[1,0]
    v_pk_add_f32 v[54:55], v[222:223], v[40:41] op_sel_hi:[1,0] neg_lo:[0,1] neg_hi:[0,1]
    v_pk_fma_f32 v[222:223], v[54:55], v[52:53], v[222:223]
    v_pk_fma_f32 v[54:55], v[222:223], v[44:45], v[46:47] op_sel_hi:[1,0,0] neg_lo:[0,0,1] neg_hi:[0,0,1]
    v_cvt_pk_bf16_f32 v77, v54, v55
    v_pk_mul_f32 v[48:49], v[204:205], v[42:43] op_sel_hi:[1,0]
    v_pk_add_f32 v[50:51], v[224:225], v[40:41] op_sel_hi:[1,0] neg_lo:[0,1] neg_hi:[0,1]
    v_pk_fma_f32 v[224:225], v[50:51], v[48:49], v[224:225]
    v_pk_fma_f32 v[50:51], v[224:225], v[44:45], v[46:47] op_sel_hi:[1,0,0] neg_lo:[0,0,1] neg_hi:[0,0,1]
    v_cvt_pk_bf16_f32 v78, v50, v51
    v_pk_mul_f32 v[52:53], v[206:207], v[42:43] op_sel_hi:[1,0]
    v_pk_add_f32 v[54:55], v[226:227], v[40:41] op_sel_hi:[1,0] neg_lo:[0,1] neg_hi:[0,1]
    v_pk_fma_f32 v[226:227], v[54:55], v[52:53], v[226:227]
    v_pk_fma_f32 v[54:55], v[226:227], v[44:45], v[46:47] op_sel_hi:[1,0,0] neg_lo:[0,0,1] neg_hi:[0,0,1]
    v_cvt_pk_bf16_f32 v79, v54, v55
    buffer_store_dwordx4 v[76:79], v2, s[32:35], s82 offen offset:1024
    v_pk_mul_f32 v[48:49], v[208:209], v[42:43] op_sel_hi:[1,0]
    v_pk_add_f32 v[50:51], v[228:229], v[40:41] op_sel_hi:[1,0] neg_lo:[0,1] neg_hi:[0,1]
    v_pk_fma_f32 v[228:229], v[50:51], v[48:49], v[228:229]
    v_pk_fma_f32 v[50:51], v[228:229], v[44:45], v[46:47] op_sel_hi:[1,0,0] neg_lo:[0,0,1] neg_hi:[0,0,1]
    v_cvt_pk_bf16_f32 v80, v50, v51
    v_pk_mul_f32 v[52:53], v[210:211], v[42:43] op_sel_hi:[1,0]
    v_pk_add_f32 v[54:55], v[230:231], v[40:41] op_sel_hi:[1,0] neg_lo:[0,1] neg_hi:[0,1]
    v_pk_fma_f32 v[230:231], v[54:55], v[52:53], v[230:231]
    v_pk_fma_f32 v[54:55], v[230:231], v[44:45], v[46:47] op_sel_hi:[1,0,0] neg_lo:[0,0,1] neg_hi:[0,0,1]
    v_cvt_pk_bf16_f32 v81, v54, v55
    buffer_store_dwordx2 v[80:81], v2, s[32:35], s83 offen
    s_waitcnt vmcnt(3)
    v_lshlrev_b32 v44, 16, v84
    v_and_b32 v45, s93, v84
    v_pk_mul_f32 v[44:45], v[44:45], s[30:31] op_sel_hi:[1,0]
    v_lshlrev_b32 v46, 16, v85
    v_and_b32 v47, s93, v85
    v_pk_mul_f32 v[46:47], v[46:47], s[30:31] op_sel_hi:[1,0]
    v_lshlrev_b32 v48, 16, v86
    v_and_b32 v49, s93, v86
    v_pk_mul_f32 v[48:49], v[48:49], s[30:31] op_sel_hi:[1,0]
    v_lshlrev_b32 v50, 16, v87
    v_and_b32 v51, s93, v87
    v_pk_mul_f32 v[50:51], v[50:51], s[30:31] op_sel_hi:[1,0]
    v_lshlrev_b32 v52, 16, v88
    v_and_b32 v53, s93, v88
    v_pk_mul_f32 v[52:53], v[52:53], s[30:31] op_sel_hi:[1,0]
    v_lshlrev_b32 v54, 16, v89
    v_and_b32 v55, s93, v89
    v_pk_mul_f32 v[54:55], v[54:55], s[30:31] op_sel_hi:[1,0]
    v_lshlrev_b32 v56, 16, v90
    v_and_b32 v57, s93, v90
    v_pk_mul_f32 v[56:57], v[56:57], s[30:31] op_sel_hi:[1,0]
    v_lshlrev_b32 v58, 16, v91
    v_and_b32 v59, s93, v91
    v_pk_mul_f32 v[58:59], v[58:59], s[30:31] op_sel_hi:[1,0]
    v_lshlrev_b32 v60, 16, v92
    v_and_b32 v61, s93, v92
    v_pk_mul_f32 v[60:61], v[60:61], s[30:31] op_sel_hi:[1,0]
    v_lshlrev_b32 v62, 16, v93
    v_and_b32 v63, s93, v93
    v_pk_mul_f32 v[62:63], v[62:63], s[30:31] op_sel_hi:[1,0]
    v_lshlrev_b32 v64, 16, v94
    v_and_b32 v65, s93, v94
    v_pk_mul_f32 v[64:65], v[64:65], s[30:31] op_sel_hi:[1,0]
    v_lshlrev_b32 v66, 16, v95
    v_and_b32 v67, s93, v95
    v_pk_mul_f32 v[66:67], v[66:67], s[30:31] op_sel_hi:[1,0]
    v_lshlrev_b32 v68, 16, v96
    v_and_b32 v69, s93, v96
    v_pk_mul_f32 v[68:69], v[68:69], s[30:31] op_sel_hi:[1,0]
    v_lshlrev_b32 v70, 16, v97
    v_and_b32 v71, s93, v97
    v_pk_mul_f32 v[70:71], v[70:71], s[30:31] op_sel_hi:[1,0]
    s_cmp_eq_u32 s10, 0
    s_cbranch_scc1 ool_30
back_31:
    s_cmp_lg_u32 s11, 0
    s_waitcnt vmcnt(0)
    s_mov_b64 exec, 1
    s_cbranch_scc1 pubs_32
    buffer_store_dword v190, v191, s[32:35], s84 offen
pubb_33:
    s_mov_b64 exec, -1
    buffer_load_dword v180, v6, s[32:35], s85 offen offset:1024 sc1
    s_cmp_eq_u32 s10, 0
    s_cbranch_scc1 ool_38
back_39:
    ds_read_b128 v[72:75], v2 offset:0
    ds_read_b128 v[76:79], v2 offset:1024
    ds_read_b128 v[80:83], v2 offset:2048
    ds_read_b128 v[84:87], v2 offset:3072
    ds_read_b128 v[88:91], v2 offset:4096
    ds_read_b128 v[92:95], v2 offset:5120
    ds_read_b128 v[96:99], v2 offset:6144
    s_add_u32 s84, s84, 512
    s_xor_b32 s66, s66, 0x40000000
    s_mov_b32 s97, 0
poll_34:
    s_waitcnt vmcnt(0)
    v_cmp_ne_u32 vcc, s13, v180
    s_cbranch_vccnz pretry_36
pdone_35:
    s_cmp_lg_u32 s11, 0
    s_cbranch_scc1 ool_40
back_41:
    s_cmp_lg_u32 s10, 0
    s_cbranch_scc1 L_g1b
    buffer_load_dwordx4 v[100:103], v2, s[32:35], s14 offen offset:0 sc1
    buffer_load_dwordx4 v[104:107], v2, s[32:35], s14 offen offset:2048 sc1
    buffer_load_dwordx4 v[108:111], v2, s[32:35], s14 offen offset:1024 sc1
    buffer_load_dwordx4 v[112:115], v2, s[32:35], s14 offen offset:3072 sc1
    s_cmp_eq_u32 s10, 0
    s_cselect_b64 vcc, -1, 0
    s_add_u32 s85, s85, 512
    s_waitcnt vmcnt(2)
    s_waitcnt lgkmcnt(5)
    v_mfma_f32_16x16x32_bf16 v[16:19], v[72:75], v[100:103], v[44:47]
    v_mfma_f32_16x16x32_bf16 v[44:47], v[72:75], v[104:107], v[44:47]
    ds_read_b128 v[72:75], v2 offset:7168
    v_mfma_f32_16x16x32_bf16 v[20:23], v[76:79], v[100:103], v[48:51]
    v_mfma_f32_16x16x32_bf16 v[48:51], v[76:79], v[104:107], v[48:51]
    ds_read_b128 v[76:79], v2 offset:8192
    buffer_load_dwordx4 v[116:119], v2, s[32:35], s22 offen offset:0 sc1
    s_waitcnt lgkmcnt(5)
    v_mfma_f32_16x16x32_bf16 v[24:27], v[80:83], v[100:103], v[52:55]
    v_mfma_f32_16x16x32_bf16 v[52:55], v[80:83], v[104:107], v[52:55]
    ds_read_b128 v[80:83], v2 offset:9216
    v_mfma_f32_16x16x32_bf16 v[28:31], v[84:87], v[100:103], v[56:59]
    v_mfma_f32_16x16x32_bf16 v[56:59], v[84:87], v[104:107], v[56:59]
    ds_read_b128 v[84:87], v2 offset:10240
    buffer_load_dwordx4 v[120:123], v2, s[32:35], s22 offen offset:1024 sc1
    s_waitcnt lgkmcnt(5)
    v_mfma_f32_16x16x32_bf16 v[32:35], v[88:91], v[100:103], v[60:63]
    v_mfma_f32_16x16x32_bf16 v[60:63], v[88:91], v[104:107], v[60:63]
    ds_read_b128 v[88:91], v2 offset:11264
    v_mfma_f32_16x16x32_bf16 v[36:39], v[92:95], v[100:103], v[64:67]
    v_mfma_f32_16x16x32_bf16 v[64:67], v[92:95], v[104:107], v[64:67]
    ds_read_b128 v[92:95], v2 offset:12288
    buffer_load_dwordx4 v[124:127], v2, s[32:35], s15 offen offset:0 sc1
    s_waitcnt lgkmcnt(6)
    v_mfma_f32_16x16x32_bf16 v[40:43], v[96:99], v[100:103], v[68:71]
    v_mfma_f32_16x16x32_bf16 v[68:71], v[96:99], v[104:107], v[68:71]
    ds_read_b128 v[96:99], v2 offset:13312
    s_waitcnt vmcnt(3)
    s_waitcnt lgkmcnt(5)
    v_mfma_f32_16x16x32_bf16 v[16:19], v[72:75], v[108:111], v[16:19]
    v_mfma_f32_16x16x32_bf16 v[44:47], v[72:75], v[112:115], v[44:47]
    ds_read_b128 v[72:75], v2 offset:14336
    v_mfma_f32_16x16x32_bf16 v[20:23], v[76:79], v[108:111], v[20:23]
    v_mfma_f32_16x16x32_bf16 v[48:51], v[76:79], v[112:115], v[48:51]
    ds_read_b128 v[76:79], v2 offset:15360
    buffer_load_dwordx4 v[128:131], v2, s[32:35], s15 offen offset:2048 sc1
    s_waitcnt lgkmcnt(5)
    v_mfma_f32_16x16x32_bf16 v[24:27], v[80:83], v[108:111], v[24:27]
    v_mfma_f32_16x16x32_bf16 v[52:55], v[80:83], v[112:115], v[52:55]
    ds_read_b128 v[80:83], v2 offset:16384
    v_mfma_f32_16x16x32_bf16 v[28:31], v[84:87], v[108:111], v[28:31]
    v_mfma_f32_16x16x32_bf16 v[56:59], v[84:87], v[112:115], v[56:59]
    ds_read_b128 v[84:87], v2 offset:17408
    buffer_load_dwordx4 v[132:135], v2, s[32:35], s15 offen offset:1024 sc1
    s_waitcnt lgkmcnt(5)
    v_mfma_f32_16x16x32_bf16 v[32:35], v[88:91], v[108:111], v[32:35]
    v_mfma_f32_16x16x32_bf16 v[60:63], v[88:91], v[112:115], v[60:63]
    ds_read_b128 v[88:91], v2 offset:18432
    v_mfma_f32_16x16x32_bf16 v[36:39], v[92:95], v[108:111], v[36:39]
    v_mfma_f32_16x16x32_bf16 v[64:67], v[92:95], v[112:115], v[64:67]
    ds_read_b128 v[92:95], v2 offset:19456
    buffer_load_dwordx4 v[136:139], v2, s[32:35], s15 offen offset:3072 sc1
    s_waitcnt lgkmcnt(6)
    v_mfma_f32_16x16x32_bf16 v[40:43], v[96:99], v[108:111], v[40:43]
    v_mfma_f32_16x16x32_bf16 v[68:71], v[96:99], v[112:115], v[68:71]
    ds_read_b128 v[96:99], v2 offset:20480
    s_waitcnt vmcnt(4)
    s_waitcnt lgkmcnt(5)
    v_mfma_f32_16x16x32_bf16 v[16:19], v[72:75], v[116:119], v[16:19]
    v_mfma_f32_16x16x32_bf16 v[44:47], v[72:75], v[120:123], v[44:47]
    ds_read_b128 v[72:75], v2 offset:21504
    v_mfma_f32_16x16x32_bf16 v[20:23], v[76:79], v[116:119], v[20:23]
    v_mfma_f32_16x16x32_bf16 v[48:51], v[76:79], v[120:123], v[48:51]
    ds_read_b128 v[76:79], v2 offset:22528
    buffer_load_dwordx4 v[140:143], v2, s[32:35], s16 offen offset:0 sc1
    s_waitcnt lgkmcnt(5)
    v_mfma_f32_16x16x32_bf16 v[24:27], v[80:83], v[116:119], v[24:27]
    v_mfma_f32_16x16x32_bf16 v[52:55], v[80:83], v[120:123], v[52:55]
    ds_read_b128 v[80:83], v2 offset:23552
    v_mfma_f32_16x16x32_bf16 v[28:31], v[84:87], v[116:119], v[28:31]
    v_mfma_f32_16x16x32_bf16 v[56:59], v[84:87], v[120:123], v[56:59]
    ds_read_b128 v[84:87], v2 offset:24576
    buffer_load_dwordx4 v[144:147], v2, s[32:35], s16 offen offset:2048 sc1
    s_waitcnt lgkmcnt(5)
    v_mfma_f32_16x16x32_bf16 v[32:35], v[88:91], v[116:119], v[32:35]
    v_mfma_f32_16x16x32_bf16 v[60:63], v[88:91], v[120:123], v[60:63]
    ds_read_b128 v[88:91], v2 offset:25600
    v_mfma_f32_16x16x32_bf16 v[36:39], v[92:95], v[116:119], v[36:39]
    v_mfma_f32_16x16x32_bf16 v[64:67], v[92:95], v[120:123], v[64:67]
    ds_read_b128 v[92:95], v2 offset:26624
    buffer_load_dwordx4 v[148:151], v2, s[32:35], s16 offen offset:1024 sc1
    s_waitcnt lgkmcnt(6)
    v_mfma_f32_16x16x32_bf16 v[40:43], v[96:99], v[116:119], v[40:43]
    v_mfma_f32_16x16x32_bf16 v[68:71], v[96:99], v[120:123], v[68:71]
    ds_read_b128 v[96:99], v2 offset:27648
    s_waitcnt vmcnt(5)
    s_waitcnt lgkmcnt(5)
    v_mfma_f32_16x16x32_bf16 v[16:19], v[72:75], v[124:127], v[16:19]
    v_mfma_f32_16x16x32_bf16 v[44:47], v[72:75], v[128:131], v[44:47]
    ds_read_b128 v[72:75], v2 offset:28672
    v_mfma_f32_16x16x32_bf16 v[20:23], v[76:79], v[124:127], v[20:23]
    v_mfma_f32_16x16x32_bf16 v[48:51], v[76:79], v[128:131], v[48:51]
    ds_read_b128 v[76:79], v2 offset:29696
    buffer_load_dwordx4 v[152:155], v2, s[32:35], s16 offen offset:3072 sc1
    s_waitcnt lgkmcnt(5)
    v_mfma_f32_16x16x32_bf16 v[24:27], v[80:83], v[124:127], v[24:27]
    v_mfma_f32_16x16x32_bf16 v[52:55], v[80:83], v[128:131], v[52:55]
    ds_read_b128 v[80:83], v2 offset:30720
    v_mfma_f32_16x16x32_bf16 v[28:31], v[84:87], v[124:127], v[28:31]
    v_mfma_f32_16x16x32_bf16 v[56:59], v[84:87], v[128:131], v[56:59]
    ds_read_b128 v[84:87], v2 offset:31744
    buffer_load_dwordx4 v[156:159], v2, s[32:35], s23 offen offset:0 sc1
    s_waitcnt lgkmcnt(5)
    v_mfma_f32_16x16x32_bf16 v[32:35], v[88:91], v[124:127], v[32:35]
    v_mfma_f32_16x16x32_bf16 v[60:63], v[88:91], v[128:131], v[60:63]
    ds_read_b128 v[88:91], v2 offset:32768
    v_mfma_f32_16x16x32_bf16 v[36:39], v[92:95], v[124:127], v[36:39]
    v_mfma_f32_16x16x32_bf16 v[64:67], v[92:95], v[128:131], v[64:67]
    ds_read_b128 v[92:95], v2 offset:33792
    buffer_load_dwordx4 v[160:163], v2, s[32:35], s23 offen offset:1024 sc1
    s_waitcnt lgkmcnt(6)
    v_mfma_f32_16x16x32_bf16 v[40:43], v[96:99], v[124:127], v[40:43]
    v_mfma_f32_16x16x32_bf16 v[68:71], v[96:99], v[128:131], v[68:71]
    ds_read_b128 v[96:99], v2 offset:34816
    s_add_u32 s73, s73, 4096
    buffer_load_dwordx4 a[96:99], v2, s[32:35], s73 offen offset:0 sc1
    buffer_load_dwordx4 a[100:103], v2, s[32:35], s73 offen offset:1024 sc1
    buffer_load_dwordx4 a[104:107], v2, s[32:35], s73 offen offset:2048 sc1
    s_waitcnt vmcnt(9)
    s_waitcnt lgkmcnt(5)
    v_mfma_f32_16x16x32_bf16 v[16:19], v[72:75], v[132:135], v[16:19]
    v_mfma_f32_16x16x32_bf16 v[44:47], v[72:75], v[136:139], v[44:47]
    ds_read_b128 v[72:75], v2 offset:35840
    v_mfma_f32_16x16x32_bf16 v[20:23], v[76:79], v[132:135], v[20:23]
    v_mfma_f32_16x16x32_bf16 v[48:51], v[76:79], v[136:139], v[48:51]
    ds_read_b128 v[76:79], v2 offset:36864
    buffer_load_dwordx4 v[164:167], v2, s[32:35], s17 offen offset:0 sc1
    s_waitcnt lgkmcnt(5)
    v_mfma_f32_16x16x32_bf16 v[24:27], v[80:83], v[132:135], v[24:27]
    v_mfma_f32_16x16x32_bf16 v[52:55], v[80:83], v[136:139], v[52:55]
    ds_read_b128 v[80:83], v2 offset:37888
    v_mfma_f32_16x16x32_bf16 v[28:31], v[84:87], v[132:135], v[28:31]
    v_mfma_f32_16x16x32_bf16 v[56:59], v[84:87], v[136:139], v[56:59]
    ds_read_b128 v[84:87], v2 offset:38912
    buffer_load_dwordx4 v[168:171], v2, s[32:35], s17 offen offset:2048 sc1
    s_waitcnt lgkmcnt(5)
    v_mfma_f32_16x16x32_bf16 v[32:35], v[88:91], v[132:135], v[32:35]
    v_mfma_f32_16x16x32_bf16 v[60:63], v[88:91], v[136:139], v[60:63]
    ds_read_b128 v[88:91], v2 offset:39936
    v_mfma_f32_16x16x32_bf16 v[36:39], v[92:95], v[132:135], v[36:39]
    v_mfma_f32_16x16x32_bf16 v[64:67], v[92:95], v[136:139], v[64:67]
    ds_read_b128 v[92:95], v2 offset:40960
    buffer_load_dwordx4 v[172:175], v2, s[32:35], s17 offen offset:1024 sc1
    s_waitcnt lgkmcnt(6)
    v_mfma_f32_16x16x32_bf16 v[40:43], v[96:99], v[132:135], v[40:43]
    v_mfma_f32_16x16x32_bf16 v[68:71], v[96:99], v[136:139], v[68:71]
    ds_read_b128 v[96:99], v2 offset:41984
    buffer_load_dwordx4 a[108:111], v2, s[32:35], s73 offen offset:3072 sc1
    s_add_u32 s73, s73, 4096
    buffer_load_dwordx4 a[112:115], v2, s[32:35], s73 offen offset:0 sc1
    buffer_load_dwordx4 a[116:119], v2, s[32:35], s73 offen offset:1024 sc1
    s_waitcnt vmcnt(13)
    s_waitcnt lgkmcnt(5)
    v_mfma_f32_16x16x32_bf16 v[16:19], v[72:75], v[140:143], v[16:19]
    v_mfma_f32_16x16x32_bf16 v[44:47], v[72:75], v[144:147], v[44:47]
    ds_read_b128 v[72:75], v2 offset:43008
    v_mfma_f32_16x16x32_bf16 v[20:23], v[76:79], v[140:143], v[20:23]
    v_mfma_f32_16x16x32_bf16 v[48:51], v[76:79], v[144:147], v[48:51]
    ds_read_b128 v[76:79], v2 offset:44032
    buffer_load_dwordx4 v[176:179], v2, s[32:35], s17 offen offset:3072 sc1
    s_waitcnt lgkmcnt(5)
    v_mfma_f32_16x16x32_bf16 v[24:27], v[80:83], v[140:143], v[24:27]
    v_mfma_f32_16x16x32_bf16 v[52:55], v[80:83], v[144:147], v[52:55]
    ds_read_b128 v[80:83], v2 offset:45056
    v_mfma_f32_16x16x32_bf16 v[28:31], v[84:87], v[140:143], v[28:31]
    v_mfma_f32_16x16x32_bf16 v[56:59], v[84:87], v[144:147], v[56:59]
    ds_read_b128 v[84:87], v2 offset:46080
    buffer_load_dwordx4 v[100:103], v2, s[32:35], s18 offen offset:0 sc1
    s_waitcnt lgkmcnt(5)
    v_mfma_f32_16x16x32_bf16 v[32:35], v[88:91], v[140:143], v[32:35]
    v_mfma_f32_16x16x32_bf16 v[60:63], v[88:91], v[144:147], v[60:63]
    ds_read_b128 v[88:91], v2 offset:47104
    v_mfma_f32_16x16x32_bf16 v[36:39], v[92:95], v[140:143], v[36:39]
    v_mfma_f32_16x16x32_bf16 v[64:67], v[92:95], v[144:147], v[64:67]
    ds_read_b128 v[92:95], v2 offset:48128
    buffer_load_dwordx4 v[104:107], v2, s[32:35], s18 offen offset:2048 sc1
    s_waitcnt lgkmcnt(6)
    v_mfma_f32_16x16x32_bf16 v[40:43], v[96:99], v[140:143], v[40:43]
    v_mfma_f32_16x16x32_bf16 v[68:71], v[96:99], v[144:147], v[68:71]
    ds_read_b128 v[96:99], v2 offset:49152
    buffer_load_dwordx4 a[120:123], v2, s[32:35], s73 offen offset:2048 sc1
    buffer_load_dwordx4 a[124:127], v2, s[32:35], s73 offen offset:3072 sc1
    s_add_u32 s73, s73, 4096
    buffer_load_dwordx4 a[128:131], v2, s[32:35], s73 offen offset:0 sc1
    s_waitcnt vmcnt(17)
    s_waitcnt lgkmcnt(5)
    v_mfma_f32_16x16x32_bf16 v[16:19], v[72:75], v[148:151], v[16:19]
    v_mfma_f32_16x16x32_bf16 v[44:47], v[72:75], v[152:155], v[44:47]
    ds_read_b128 v[72:75], v2 offset:50176
    v_mfma_f32_16x16x32_bf16 v[20:23], v[76:79], v[148:151], v[20:23]
    v_mfma_f32_16x16x32_bf16 v[48:51], v[76:79], v[152:155], v[48:51]
    ds_read_b128 v[76:79], v2 offset:51200
    buffer_load_dwordx4 v[108:111], v2, s[32:35], s18 offen offset:1024 sc1
    s_waitcnt lgkmcnt(5)
    v_mfma_f32_16x16x32_bf16 v[24:27], v[80:83], v[148:151], v[24:27]
    v_mfma_f32_16x16x32_bf16 v[52:55], v[80:83], v[152:155], v[52:55]
    ds_read_b128 v[80:83], v2 offset:52224
    v_mfma_f32_16x16x32_bf16 v[28:31], v[84:87], v[148:151], v[28:31]
    v_mfma_f32_16x16x32_bf16 v[56:59], v[84:87], v[152:155], v[56:59]
    ds_read_b128 v[84:87], v2 offset:53248
    buffer_load_dwordx4 v[112:115], v2, s[32:35], s18 offen offset:3072 sc1
    s_waitcnt lgkmcnt(5)
    v_mfma_f32_16x16x32_bf16 v[32:35], v[88:91], v[148:151], v[32:35]
    v_mfma_f32_16x16x32_bf16 v[60:63], v[88:91], v[152:155], v[60:63]
    ds_read_b128 v[88:91], v2 offset:54272
    v_mfma_f32_16x16x32_bf16 v[36:39], v[92:95], v[148:151], v[36:39]
    v_mfma_f32_16x16x32_bf16 v[64:67], v[92:95], v[152:155], v[64:67]
    ds_read_b128 v[92:95], v2 offset:55296
    buffer_load_dwordx4 v[116:119], v2, s[32:35], s64 offen offset:0 sc1
    s_waitcnt lgkmcnt(6)
    v_mfma_f32_16x16x32_bf16 v[40:43], v[96:99], v[148:151], v[40:43]
    v_mfma_f32_16x16x32_bf16 v[68:71], v[96:99], v[152:155], v[68:71]
    ds_read_b128 v[96:99], v2 offset:56320
    buffer_load_dwordx4 a[132:135], v2, s[32:35], s73 offen offset:1024 sc1
    buffer_load_dwordx4 a[136:139], v2, s[32:35], s73 offen offset:2048 sc1
    buffer_load_dwordx4 a[140:143], v2, s[32:35], s73 offen offset:3072 sc1
    s_waitcnt vmcnt(21)
    s_waitcnt lgkmcnt(5)
    v_mfma_f32_16x16x32_bf16 v[16:19], v[72:75], v[156:159], v[16:19]
    v_mfma_f32_16x16x32_bf16 v[44:47], v[72:75], v[160:163], v[44:47]
    ds_read_b128 v[72:75], v2 offset:57344
    v_mfma_f32_16x16x32_bf16 v[20:23], v[76:79], v[156:159], v[20:23]
    v_mfma_f32_16x16x32_bf16 v[48:51], v[76:79], v[160:163], v[48:51]
    ds_read_b128 v[76:79], v2 offset:58368
    buffer_load_dwordx4 v[120:123], v2, s[32:35], s64 offen offset:1024 sc1
    s_waitcnt lgkmcnt(5)
    v_mfma_f32_16x16x32_bf16 v[24:27], v[80:83], v[156:159], v[24:27]
    v_mfma_f32_16x16x32_bf16 v[52:55], v[80:83], v[160:163], v[52:55]
    ds_read_b128 v[80:83], v2 offset:59392
    v_mfma_f32_16x16x32_bf16 v[28:31], v[84:87], v[156:159], v[28:31]
    v_mfma_f32_16x16x32_bf16 v[56:59], v[84:87], v[160:163], v[56:59]
    ds_read_b128 v[84:87], v2 offset:60416
    buffer_load_dwordx4 v[124:127], v2, s[32:35], s19 offen offset:0 sc1
    s_waitcnt lgkmcnt(5)
    v_mfma_f32_16x16x32_bf16 v[32:35], v[88:91], v[156:159], v[32:35]
    v_mfma_f32_16x16x32_bf16 v[60:63], v[88:91], v[160:163], v[60:63]
    ds_read_b128 v[88:91], v2 offset:61440
    v_mfma_f32_16x16x32_bf16 v[36:39], v[92:95], v[156:159], v[36:39]
    v_mfma_f32_16x16x32_bf16 v[64:67], v[92:95], v[160:163], v[64:67]
    ds_read_b128 v[92:95], v2 offset:62464
    buffer_load_dwordx4 v[128:131], v2, s[32:35], s19 offen offset:2048 sc1
    s_waitcnt lgkmcnt(6)
    v_mfma_f32_16x16x32_bf16 v[40:43], v[96:99], v[156:159], v[40:43]
    v_mfma_f32_16x16x32_bf16 v[68:71], v[96:99], v[160:163], v[68:71]
    ds_read_b128 v[96:99], v2 offset:63488
    s_add_u32 s73, s73, 4096
    buffer_load_dwordx4 a[144:147], v2, s[32:35], s73 offen offset:0 sc1
    buffer_load_dwordx4 a[148:151], v2, s[32:35], s73 offen offset:1024 sc1
    buffer_load_dwordx4 a[152:155], v2, s[32:35], s73 offen offset:2048 sc1
    s_waitcnt vmcnt(22)
    s_waitcnt lgkmcnt(5)
    v_mfma_f32_16x16x32_bf16 v[16:19], v[72:75], v[164:167], v[16:19]
    v_mfma_f32_16x16x32_bf16 v[44:47], v[72:75], v[168:171], v[44:47]
    ds_read_b128 v[72:75], v4 offset:0
    v_mfma_f32_16x16x32_bf16 v[20:23], v[76:79], v[164:167], v[20:23]
    v_mfma_f32_16x16x32_bf16 v[48:51], v[76:79], v[168:171], v[48:51]
    ds_read_b128 v[76:79], v4 offset:1024
    buffer_load_dwordx4 v[132:135], v2, s[32:35], s19 offen offset:1024 sc1
    s_waitcnt lgkmcnt(5)
    v_mfma_f32_16x16x32_bf16 v[24:27], v[80:83], v[164:167], v[24:27]
    v_mfma_f32_16x16x32_bf16 v[52:55], v[80:83], v[168:171], v[52:55]
    ds_read_b128 v[80:83], v4 offset:2048
    v_mfma_f32_16x16x32_bf16 v[28:31], v[84:87], v[164:167], v[28:31]
    v_mfma_f32_16x16x32_bf16 v[56:59], v[84:87], v[168:171], v[56:59]
    ds_read_b128 v[84:87], v4 offset:3072
    buffer_load_dwordx4 v[136:139], v2, s[32:35], s19 offen offset:3072 sc1
    s_waitcnt lgkmcnt(5)
    v_mfma_f32_16x16x32_bf16 v[32:35], v[88:91], v[164:167], v[32:35]
    v_mfma_f32_16x16x32_bf16 v[60:63], v[88:91], v[168:171], v[60:63]
    ds_read_b128 v[88:91], v4 offset:4096
    v_mfma_f32_16x16x32_bf16 v[36:39], v[92:95], v[164:167], v[36:39]
    v_mfma_f32_16x16x32_bf16 v[64:67], v[92:95], v[168:171], v[64:67]
    ds_read_b128 v[92:95], v4 offset:5120
    buffer_load_dwordx4 v[140:143], v2, s[32:35], s20 offen offset:0 sc1
    s_waitcnt lgkmcnt(6)
    v_mfma_f32_16x16x32_bf16 v[40:43], v[96:99], v[164:167], v[40:43]
    v_mfma_f32_16x16x32_bf16 v[68:71], v[96:99], v[168:171], v[68:71]
    ds_read_b128 v[96:99], v4 offset:6144
    buffer_load_dwordx4 a[156:159], v2, s[32:35], s73 offen offset:3072 sc1
    s_add_u32 s73, s73, 4096
    buffer_load_dwordx4 a[160:163], v2, s[32:35], s73 offen offset:0 sc1
    buffer_load_dwordx4 a[164:167], v2, s[32:35], s73 offen offset:1024 sc1
    s_waitcnt vmcnt(23)
    s_waitcnt lgkmcnt(5)
    v_mfma_f32_16x16x32_bf16 v[16:19], v[72:75], v[172:175], v[16:19]
    v_mfma_f32_16x16x32_bf16 v[44:47], v[72:75], v[176:179], v[44:47]
    ds_read_b128 v[72:75], v4 offset:7168
    v_mfma_f32_16x16x32_bf16 v[20:23], v[76:79], v[172:175], v[20:23]
    v_mfma_f32_16x16x32_bf16 v[48:51], v[76:79], v[176:179], v[48:51]
    ds_read_b128 v[76:79], v4 offset:8192
    buffer_load_dwordx4 v[144:147], v2, s[32:35], s20 offen offset:2048 sc1
    s_waitcnt lgkmcnt(5)
    v_mfma_f32_16x16x32_bf16 v[24:27], v[80:83], v[172:175], v[24:27]
    v_mfma_f32_16x16x32_bf16 v[52:55], v[80:83], v[176:179], v[52:55]
    ds_read_b128 v[80:83], v4 offset:9216
    v_mfma_f32_16x16x32_bf16 v[28:31], v[84:87], v[172:175], v[28:31]
    v_mfma_f32_16x16x32_bf16 v[56:59], v[84:87], v[176:179], v[56:59]
    ds_read_b128 v[84:87], v4 offset:10240
    buffer_load_dwordx4 v[148:151], v2, s[32:35], s20 offen offset:1024 sc1
    s_waitcnt lgkmcnt(5)
    v_mfma_f32_16x16x32_bf16 v[32:35], v[88:91], v[172:175], v[32:35]
    v_mfma_f32_16x16x32_bf16 v[60:63], v[88:91], v[176:179], v[60:63]
    ds_read_b128 v[88:91], v4 offset:11264
    v_mfma_f32_16x16x32_bf16 v[36:39], v[92:95], v[172:175], v[36:39]
    v_mfma_f32_16x16x32_bf16 v[64:67], v[92:95], v[176:179], v[64:67]
    ds_read_b128 v[92:95], v4 offset:12288
    buffer_load_dwordx4 v[152:155], v2, s[32:35], s20 offen offset:3072 sc1
    s_waitcnt lgkmcnt(6)
    v_mfma_f32_16x16x32_bf16 v[40:43], v[96:99], v[172:175], v[40:43]
    v_mfma_f32_16x16x32_bf16 v[68:71], v[96:99], v[176:179], v[68:71]
    ds_read_b128 v[96:99], v4 offset:13312
    buffer_load_dwordx4 a[168:171], v2, s[32:35], s73 offen offset:2048 sc1
    buffer_load_dwordx4 a[172:175], v2, s[32:35], s73 offen offset:3072 sc1
    s_add_u32 s73, s73, 4096
    buffer_load_dwordx4 a[176:179], v2, s[32:35], s73 offen offset:0 sc1
    s_waitcnt vmcnt(27)
    s_waitcnt lgkmcnt(5)
    v_mfma_f32_16x16x32_bf16 v[16:19], v[72:75], v[100:103], v[16:19]
    v_mfma_f32_16x16x32_bf16 v[44:47], v[72:75], v[104:107], v[44:47]
    ds_read_b128 v[72:75], v4 offset:14336
    v_mfma_f32_16x16x32_bf16 v[20:23], v[76:79], v[100:103], v[20:23]
    v_mfma_f32_16x16x32_bf16 v[48:51], v[76:79], v[104:107], v[48:51]
    ds_read_b128 v[76:79], v4 offset:15360
    buffer_load_dwordx4 v[156:159], v2, s[32:35], s65 offen offset:0 sc1
    s_waitcnt lgkmcnt(5)
    v_mfma_f32_16x16x32_bf16 v[24:27], v[80:83], v[100:103], v[24:27]
    v_mfma_f32_16x16x32_bf16 v[52:55], v[80:83], v[104:107], v[52:55]
    ds_read_b128 v[80:83], v4 offset:16384
    v_mfma_f32_16x16x32_bf16 v[28:31], v[84:87], v[100:103], v[28:31]
    v_mfma_f32_16x16x32_bf16 v[56:59], v[84:87], v[104:107], v[56:59]
    ds_read_b128 v[84:87], v4 offset:17408
    buffer_load_dwordx4 v[160:163], v2, s[32:35], s65 offen offset:1024 sc1
    s_waitcnt lgkmcnt(5)
    v_mfma_f32_16x16x32_bf16 v[32:35], v[88:91], v[100:103], v[32:35]
    v_mfma_f32_16x16x32_bf16 v[60:63], v[88:91], v[104:107], v[60:63]
    ds_read_b128 v[88:91], v4 offset:18432
    v_mfma_f32_16x16x32_bf16 v[36:39], v[92:95], v[100:103], v[36:39]
    v_mfma_f32_16x16x32_bf16 v[64:67], v[92:95], v[104:107], v[64:67]
    ds_read_b128 v[92:95], v4 offset:19456
    buffer_load_dwordx4 v[164:167], v2, s[32:35], s21 offen offset:0 sc1
    s_waitcnt lgkmcnt(6)
    v_mfma_f32_16x16x32_bf16 v[40:43], v[96:99], v[100:103], v[40:43]
    v_mfma_f32_16x16x32_bf16 v[68:71], v[96:99], v[104:107], v[68:71]
    ds_read_b128 v[96:99], v4 offset:20480
    buffer_load_dwordx4 a[180:183], v2, s[32:35], s73 offen offset:1024 sc1
    buffer_load_dwordx4 a[184:187], v2, s[32:35], s73 offen offset:2048 sc1
    buffer_load_dwordx4 a[188:191], v2, s[32:35], s73 offen offset:3072 sc1
    s_waitcnt vmcnt(28)
    s_waitcnt lgkmcnt(5)
    v_mfma_f32_16x16x32_bf16 v[16:19], v[72:75], v[108:111], v[16:19]
    v_mfma_f32_16x16x32_bf16 v[44:47], v[72:75], v[112:115], v[44:47]
    ds_read_b128 v[72:75], v4 offset:21504
    v_mfma_f32_16x16x32_bf16 v[20:23], v[76:79], v[108:111], v[20:23]
    v_mfma_f32_16x16x32_bf16 v[48:51], v[76:79], v[112:115], v[48:51]
    ds_read_b128 v[76:79], v4 offset:22528
    buffer_load_dwordx4 v[168:171], v2, s[32:35], s21 offen offset:2048 sc1
    s_waitcnt lgkmcnt(5)
    v_mfma_f32_16x16x32_bf16 v[24:27], v[80:83], v[108:111], v[24:27]
    v_mfma_f32_16x16x32_bf16 v[52:55], v[80:83], v[112:115], v[52:55]
    ds_read_b128 v[80:83], v4 offset:23552
    v_mfma_f32_16x16x32_bf16 v[28:31], v[84:87], v[108:111], v[28:31]
    v_mfma_f32_16x16x32_bf16 v[56:59], v[84:87], v[112:115], v[56:59]
    ds_read_b128 v[84:87], v4 offset:24576
    buffer_load_dwordx4 v[172:175], v2, s[32:35], s21 offen offset:1024 sc1
    s_waitcnt lgkmcnt(5)
    v_mfma_f32_16x16x32_bf16 v[32:35], v[88:91], v[108:111], v[32:35]
    v_mfma_f32_16x16x32_bf16 v[60:63], v[88:91], v[112:115], v[60:63]
    ds_read_b128 v[88:91], v4 offset:25600
    v_mfma_f32_16x16x32_bf16 v[36:39], v[92:95], v[108:111], v[36:39]
    v_mfma_f32_16x16x32_bf16 v[64:67], v[92:95], v[112:115], v[64:67]
    ds_read_b128 v[92:95], v4 offset:26624
    buffer_load_dwordx4 v[176:179], v2, s[32:35], s21 offen offset:3072 sc1
    s_waitcnt lgkmcnt(6)
    v_mfma_f32_16x16x32_bf16 v[40:43], v[96:99], v[108:111], v[40:43]
    v_mfma_f32_16x16x32_bf16 v[68:71], v[96:99], v[112:115], v[68:71]
    ds_read_b128 v[96:99], v4 offset:27648
    s_add_u32 s73, s73, 4096
    buffer_load_dwordx4 a[192:195], v2, s[32:35], s73 offen offset:0 sc1
    buffer_load_dwordx4 a[196:199], v2, s[32:35], s73 offen offset:1024 sc1
    buffer_load_dwordx4 a[200:203], v2, s[32:35], s73 offen offset:2048 sc1
    s_waitcnt vmcnt(29)
    s_waitcnt lgkmcnt(5)
    v_mfma_f32_16x16x32_bf16 v[16:19], v[72:75], v[116:119], v[16:19]
    v_mfma_f32_16x16x32_bf16 v[44:47], v[72:75], v[120:123], v[44:47]
    ds_read_b128 v[72:75], v4 offset:28672
    v_mfma_f32_16x16x32_bf16 v[20:23], v[76:79], v[116:119], v[20:23]
    v_mfma_f32_16x16x32_bf16 v[48:51], v[76:79], v[120:123], v[48:51]
    ds_read_b128 v[76:79], v4 offset:29696
    s_waitcnt lgkmcnt(5)
    v_mfma_f32_16x16x32_bf16 v[24:27], v[80:83], v[116:119], v[24:27]
    v_mfma_f32_16x16x32_bf16 v[52:55], v[80:83], v[120:123], v[52:55]
    ds_read_b128 v[80:83], v4 offset:30720
    v_mfma_f32_16x16x32_bf16 v[28:31], v[84:87], v[116:119], v[28:31]
    v_mfma_f32_16x16x32_bf16 v[56:59], v[84:87], v[120:123], v[56:59]
    ds_read_b128 v[84:87], v4 offset:31744
    s_waitcnt lgkmcnt(5)
    v_mfma_f32_16x16x32_bf16 v[32:35], v[88:91], v[116:119], v[32:35]
    v_mfma_f32_16x16x32_bf16 v[60:63], v[88:91], v[120:123], v[60:63]
    ds_read_b128 v[88:91], v4 offset:32768
    v_mfma_f32_16x16x32_bf16 v[36:39], v[92:95], v[116:119], v[36:39]
    v_mfma_f32_16x16x32_bf16 v[64:67], v[92:95], v[120:123], v[64:67]
    ds_read_b128 v[92:95], v4 offset:33792
    s_waitcnt lgkmcnt(6)
    v_mfma_f32_16x16x32_bf16 v[40:43], v[96:99], v[116:119], v[40:43]
    v_mfma_f32_16x16x32_bf16 v[68:71], v[96:99], v[120:123], v[68:71]
    ds_read_b128 v[96:99], v4 offset:34816
    buffer_load_dwordx4 a[204:207], v2, s[32:35], s73 offen offset:3072 sc1
    s_add_u32 s73, s73, 4096
    buffer_load_dwordx4 a[208:211], v2, s[32:35], s73 offen offset:0 sc1
    buffer_load_dwordx4 a[212:215], v2, s[32:35], s73 offen offset:1024 sc1
    s_waitcnt vmcnt(30)
    s_waitcnt lgkmcnt(5)
    v_mfma_f32_16x16x32_bf16 v[16:19], v[72:75], v[124:127], v[16:19]
    v_mfma_f32_16x16x32_bf16 v[44:47], v[72:75], v[128:131], v[44:47]
    ds_read_b128 v[72:75], v4 offset:35840
    v_mfma_f32_16x16x32_bf16 v[20:23], v[76:79], v[124:127], v[20:23]
    v_mfma_f32_16x16x32_bf16 v[48:51], v[76:79], v[128:131], v[48:51]
    ds_read_b128 v[76:79], v4 offset:36864
    s_waitcnt lgkmcnt(5)
    v_mfma_f32_16x16x32_bf16 v[24:27], v[80:83], v[124:127], v[24:27]
    v_mfma_f32_16x16x32_bf16 v[52:55], v[80:83], v[128:131], v[52:55]
    ds_read_b128 v[80:83], v4 offset:37888
    v_mfma_f32_16x16x32_bf16 v[28:31], v[84:87], v[124:127], v[28:31]
    v_mfma_f32_16x16x32_bf16 v[56:59], v[84:87], v[128:131], v[56:59]
    ds_read_b128 v[84:87], v4 offset:38912
    s_waitcnt lgkmcnt(5)
    v_mfma_f32_16x16x32_bf16 v[32:35], v[88:91], v[124:127], v[32:35]
    v_mfma_f32_16x16x32_bf16 v[60:63], v[88:91], v[128:131], v[60:63]
    ds_read_b128 v[88:91], v4 offset:39936
    v_mfma_f32_16x16x32_bf16 v[36:39], v[92:95], v[124:127], v[36:39]
    v_mfma_f32_16x16x32_bf16 v[64:67], v[92:95], v[128:131], v[64:67]
    ds_read_b128 v[92:95], v4 offset:40960
    s_waitcnt lgkmcnt(6)
    v_mfma_f32_16x16x32_bf16 v[40:43], v[96:99], v[124:127], v[40:43]
    v_mfma_f32_16x16x32_bf16 v[68:71], v[96:99], v[128:131], v[68:71]
    ds_read_b128 v[96:99], v4 offset:41984
    buffer_load_dwordx4 a[216:219], v2, s[32:35], s73 offen offset:2048 sc1
    buffer_load_dwordx4 a[220:223], v2, s[32:35], s73 offen offset:3072 sc1
    s_add_u32 s73, s73, 4096
    buffer_load_dwordx4 a[224:227], v2, s[32:35], s73 offen offset:0 sc1
    s_waitcnt vmcnt(28)
    s_waitcnt lgkmcnt(5)
    v_mfma_f32_16x16x32_bf16 v[16:19], v[72:75], v[132:135], v[16:19]
    v_mfma_f32_16x16x32_bf16 v[44:47], v[72:75], v[136:139], v[44:47]
    ds_read_b128 v[72:75], v4 offset:43008
    v_mfma_f32_16x16x32_bf16 v[20:23], v[76:79], v[132:135], v[20:23]
    v_mfma_f32_16x16x32_bf16 v[48:51], v[76:79], v[136:139], v[48:51]
    ds_read_b128 v[76:79], v4 offset:44032
    s_waitcnt lgkmcnt(5)
    v_mfma_f32_16x16x32_bf16 v[24:27], v[80:83], v[132:135], v[24:27]
    v_mfma_f32_16x16x32_bf16 v[52:55], v[80:83], v[136:139], v[52:55]
    ds_read_b128 v[80:83], v4 offset:45056
    v_mfma_f32_16x16x32_bf16 v[28:31], v[84:87], v[132:135], v[28:31]
    v_mfma_f32_16x16x32_bf16 v[56:59], v[84:87], v[136:139], v[56:59]
    ds_read_b128 v[84:87], v4 offset:46080
    s_waitcnt lgkmcnt(5)
    v_mfma_f32_16x16x32_bf16 v[32:35], v[88:91], v[132:135], v[32:35]
    v_mfma_f32_16x16x32_bf16 v[60:63], v[88:91], v[136:139], v[60:63]
    ds_read_b128 v[88:91], v4 offset:47104
    v_mfma_f32_16x16x32_bf16 v[36:39], v[92:95], v[132:135], v[36:39]
    v_mfma_f32_16x16x32_bf16 v[64:67], v[92:95], v[136:139], v[64:67]
    ds_read_b128 v[92:95], v4 offset:48128
    s_waitcnt lgkmcnt(6)
    v_mfma_f32_16x16x32_bf16 v[40:43], v[96:99], v[132:135], v[40:43]
    v_mfma_f32_16x16x32_bf16 v[68:71], v[96:99], v[136:139], v[68:71]
    ds_read_b128 v[96:99], v4 offset:49152
    buffer_load_dwordx4 a[228:231], v2, s[32:35], s73 offen offset:1024 sc1
    buffer_load_dwordx4 a[232:235], v2, s[32:35], s73 offen offset:2048 sc1
    buffer_load_dwordx4 a[236:239], v2, s[32:35], s73 offen offset:3072 sc1
    s_waitcnt vmcnt(26)
    s_waitcnt lgkmcnt(5)
    v_mfma_f32_16x16x32_bf16 v[16:19], v[72:75], v[140:143], v[16:19]
    v_mfma_f32_16x16x32_bf16 v[44:47], v[72:75], v[144:147], v[44:47]
    ds_read_b128 v[72:75], v4 offset:50176
    v_mfma_f32_16x16x32_bf16 v[20:23], v[76:79], v[140:143], v[20:23]
    v_mfma_f32_16x16x32_bf16 v[48:51], v[76:79], v[144:147], v[48:51]
    ds_read_b128 v[76:79], v4 offset:51200
    s_waitcnt lgkmcnt(5)
    v_mfma_f32_16x16x32_bf16 v[24:27], v[80:83], v[140:143], v[24:27]
    v_mfma_f32_16x16x32_bf16 v[52:55], v[80:83], v[144:147], v[52:55]
    ds_read_b128 v[80:83], v4 offset:52224
    v_mfma_f32_16x16x32_bf16 v[28:31], v[84:87], v[140:143], v[28:31]
    v_mfma_f32_16x16x32_bf16 v[56:59], v[84:87], v[144:147], v[56:59]
    ds_read_b128 v[84:87], v4 offset:53248
    s_waitcnt lgkmcnt(5)
    v_mfma_f32_16x16x32_bf16 v[32:35], v[88:91], v[140:143], v[32:35]
    v_mfma_f32_16x16x32_bf16 v[60:63], v[88:91], v[144:147], v[60:63]
    ds_read_b128 v[88:91], v4 offset:54272
    v_mfma_f32_16x16x32_bf16 v[36:39], v[92:95], v[140:143], v[36:39]
    v_mfma_f32_16x16x32_bf16 v[64:67], v[92:95], v[144:147], v[64:67]
    ds_read_b128 v[92:95], v4 offset:55296
    s_waitcnt lgkmcnt(6)
    v_mfma_f32_16x16x32_bf16 v[40:43], v[96:99], v[140:143], v[40:43]
    v_mfma_f32_16x16x32_bf16 v[68:71], v[96:99], v[144:147], v[68:71]
    ds_read_b128 v[96:99], v4 offset:56320
    s_add_u32 s73, s73, 4096
    buffer_load_dwordx4 a[240:243], v2, s[32:35], s73 offen offset:0 sc1
    buffer_load_dwordx4 a[244:247], v2, s[32:35], s73 offen offset:1024 sc1
    buffer_load_dwordx4 a[248:251], v2, s[32:35], s73 offen offset:2048 sc1
    s_waitcnt vmcnt(27)
    s_waitcnt lgkmcnt(5)
    v_mfma_f32_16x16x32_bf16 v[16:19], v[72:75], v[148:151], v[16:19]
    v_mfma_f32_16x16x32_bf16 v[44:47], v[72:75], v[152:155], v[44:47]
    ds_read_b128 v[72:75], v4 offset:57344
    v_mfma_f32_16x16x32_bf16 v[20:23], v[76:79], v[148:151], v[20:23]
    v_mfma_f32_16x16x32_bf16 v[48:51], v[76:79], v[152:155], v[48:51]
    ds_read_b128 v[76:79], v4 offset:58368
    s_waitcnt lgkmcnt(5)
    v_mfma_f32_16x16x32_bf16 v[24:27], v[80:83], v[148:151], v[24:27]
    v_mfma_f32_16x16x32_bf16 v[52:55], v[80:83], v[152:155], v[52:55]
    ds_read_b128 v[80:83], v4 offset:59392
    v_mfma_f32_16x16x32_bf16 v[28:31], v[84:87], v[148:151], v[28:31]
    v_mfma_f32_16x16x32_bf16 v[56:59], v[84:87], v[152:155], v[56:59]
    ds_read_b128 v[84:87], v4 offset:60416
    s_waitcnt lgkmcnt(5)
    v_mfma_f32_16x16x32_bf16 v[32:35], v[88:91], v[148:151], v[32:35]
    v_mfma_f32_16x16x32_bf16 v[60:63], v[88:91], v[152:155], v[60:63]
    ds_read_b128 v[88:91], v4 offset:61440
    v_mfma_f32_16x16x32_bf16 v[36:39], v[92:95], v[148:151], v[36:39]
    v_mfma_f32_16x16x32_bf16 v[64:67], v[92:95], v[152:155], v[64:67]
    ds_read_b128 v[92:95], v4 offset:62464
    s_waitcnt lgkmcnt(6)
    v_mfma_f32_16x16x32_bf16 v[40:43], v[96:99], v[148:151], v[40:43]
    v_mfma_f32_16x16x32_bf16 v[68:71], v[96:99], v[152:155], v[68:71]
    ds_read_b128 v[96:99], v4 offset:63488
    buffer_load_dwordx4 a[252:255], v2, s[32:35], s73 offen offset:3072 sc1
    s_add_u32 s73, s73, 4096
    buffer_load_dwordx4 v[232:235], v2, s[32:35], s73 offen offset:0 sc1
    buffer_load_dwordx4 v[236:239], v2, s[32:35], s73 offen offset:1024 sc1
    s_waitcnt vmcnt(25)
    s_waitcnt lgkmcnt(5)
    v_mfma_f32_16x16x32_bf16 v[16:19], v[72:75], v[156:159], v[16:19]
    v_mfma_f32_16x16x32_bf16 v[44:47], v[72:75], v[160:163], v[44:47]
    ds_read_b128 v[72:75], v5 offset:0
    v_mfma_f32_16x16x32_bf16 v[20:23], v[76:79], v[156:159], v[20:23]
    v_mfma_f32_16x16x32_bf16 v[48:51], v[76:79], v[160:163], v[48:51]
    ds_read_b128 v[76:79], v5 offset:1024
    s_waitcnt lgkmcnt(5)
    v_mfma_f32_16x16x32_bf16 v[24:27], v[80:83], v[156:159], v[24:27]
    v_mfma_f32_16x16x32_bf16 v[52:55], v[80:83], v[160:163], v[52:55]
    ds_read_b128 v[80:83], v5 offset:2048
    v_mfma_f32_16x16x32_bf16 v[28:31], v[84:87], v[156:159], v[28:31]
    v_mfma_f32_16x16x32_bf16 v[56:59], v[84:87], v[160:163], v[56:59]
    ds_read_b128 v[84:87], v5 offset:3072
    s_waitcnt lgkmcnt(5)
    v_mfma_f32_16x16x32_bf16 v[32:35], v[88:91], v[156:159], v[32:35]
    v_mfma_f32_16x16x32_bf16 v[60:63], v[88:91], v[160:163], v[60:63]
    ds_read_b128 v[88:91], v5 offset:4096
    v_mfma_f32_16x16x32_bf16 v[36:39], v[92:95], v[156:159], v[36:39]
    v_mfma_f32_16x16x32_bf16 v[64:67], v[92:95], v[160:163], v[64:67]
    ds_read_b128 v[92:95], v5 offset:5120
    s_waitcnt lgkmcnt(6)
    v_mfma_f32_16x16x32_bf16 v[40:43], v[96:99], v[156:159], v[40:43]
    v_mfma_f32_16x16x32_bf16 v[68:71], v[96:99], v[160:163], v[68:71]
    ds_read_b128 v[96:99], v5 offset:6144
    buffer_load_dwordx4 v[240:243], v2, s[32:35], s73 offen offset:2048 sc1
    buffer_load_dwordx4 v[244:247], v2, s[32:35], s73 offen offset:3072 sc1
    s_add_u32 s73, s73, 4096
    buffer_load_dwordx4 v[248:251], v2, s[32:35], s73 offen offset:0 sc1
    s_waitcnt vmcnt(23)
    s_waitcnt lgkmcnt(5)
    v_mfma_f32_16x16x32_bf16 v[16:19], v[72:75], v[164:167], v[16:19]
    v_mfma_f32_16x16x32_bf16 v[44:47], v[72:75], v[168:171], v[44:47]
    ds_read_b128 v[72:75], v5 offset:7168
    v_mfma_f32_16x16x32_bf16 v[20:23], v[76:79], v[164:167], v[20:23]
    v_mfma_f32_16x16x32_bf16 v[48:51], v[76:79], v[168:171], v[48:51]
    ds_read_b128 v[76:79], v5 offset:8192
    s_waitcnt lgkmcnt(5)
    v_mfma_f32_16x16x32_bf16 v[24:27], v[80:83], v[164:167], v[24:27]
    v_mfma_f32_16x16x32_bf16 v[52:55], v[80:83], v[168:171], v[52:55]
    ds_read_b128 v[80:83], v5 offset:9216
    v_mfma_f32_16x16x32_bf16 v[28:31], v[84:87], v[164:167], v[28:31]
    v_mfma_f32_16x16x32_bf16 v[56:59], v[84:87], v[168:171], v[56:59]
    ds_read_b128 v[84:87], v5 offset:10240
    s_waitcnt lgkmcnt(5)
    v_mfma_f32_16x16x32_bf16 v[32:35], v[88:91], v[164:167], v[32:35]
    v_mfma_f32_16x16x32_bf16 v[60:63], v[88:91], v[168:171], v[60:63]
    ds_read_b128 v[88:91], v5 offset:11264
    v_mfma_f32_16x16x32_bf16 v[36:39], v[92:95], v[164:167], v[36:39]
    v_mfma_f32_16x16x32_bf16 v[64:67], v[92:95], v[168:171], v[64:67]
    ds_read_b128 v[92:95], v5 offset:12288
    s_waitcnt lgkmcnt(6)
    v_mfma_f32_16x16x32_bf16 v[40:43], v[96:99], v[164:167], v[40:43]
    v_mfma_f32_16x16x32_bf16 v[68:71], v[96:99], v[168:171], v[68:71]
    ds_read_b128 v[96:99], v5 offset:13312
    buffer_load_dwordx4 v[252:255], v2, s[32:35], s73 offen offset:1024 sc1
    s_waitcnt vmcnt(22)
    s_waitcnt lgkmcnt(5)
    v_mfma_f32_16x16x32_bf16 v[16:19], v[72:75], v[172:175], v[16:19]
    v_mfma_f32_16x16x32_bf16 v[44:47], v[72:75], v[176:179], v[44:47]
    v_mfma_f32_16x16x32_bf16 v[20:23], v[76:79], v[172:175], v[20:23]
    v_mfma_f32_16x16x32_bf16 v[48:51], v[76:79], v[176:179], v[48:51]
    s_waitcnt lgkmcnt(3)
    v_mfma_f32_16x16x32_bf16 v[24:27], v[80:83], v[172:175], v[24:27]
    v_mfma_f32_16x16x32_bf16 v[52:55], v[80:83], v[176:179], v[52:55]
    v_mfma_f32_16x16x32_bf16 v[28:31], v[84:87], v[172:175], v[28:31]
    v_mfma_f32_16x16x32_bf16 v[56:59], v[84:87], v[176:179], v[56:59]
    s_waitcnt lgkmcnt(1)
    v_mfma_f32_16x16x32_bf16 v[32:35], v[88:91], v[172:175], v[32:35]
    v_mfma_f32_16x16x32_bf16 v[60:63], v[88:91], v[176:179], v[60:63]
    v_mfma_f32_16x16x32_bf16 v[36:39], v[92:95], v[172:175], v[36:39]
    v_mfma_f32_16x16x32_bf16 v[64:67], v[92:95], v[176:179], v[64:67]
    s_waitcnt lgkmcnt(0)
    v_mfma_f32_16x16x32_bf16 v[40:43], v[96:99], v[172:175], v[40:43]
    v_mfma_f32_16x16x32_bf16 v[68:71], v[96:99], v[176:179], v[68:71]
    s_branch L_g1e
L_g1b:
    buffer_load_dwordx4 v[100:103], v2, s[32:35], s14 offen offset:0 sc1
    buffer_load_dwordx4 v[104:107], v2, s[32:35], s14 offen offset:2048 sc1
    buffer_load_dwordx4 v[108:111], v2, s[32:35], s14 offen offset:1024 sc1
    buffer_load_dwordx4 v[112:115], v2, s[32:35], s14 offen offset:3072 sc1
    s_cmp_eq_u32 s10, 0
    s_cselect_b64 vcc, -1, 0
    s_add_u32 s85, s85, 512
    s_waitcnt vmcnt(2)
    s_waitcnt lgkmcnt(5)
    v_mfma_f32_16x16x32_bf16 v[16:19], v[72:75], v[100:103], v[44:47]
    v_mfma_f32_16x16x32_bf16 v[44:47], v[72:75], v[104:107], v[44:47]
    ds_read_b128 v[72:75], v2 offset:7168
    v_mfma_f32_16x16x32_bf16 v[20:23], v[76:79], v[100:103], v[48:51]
    v_mfma_f32_16x16x32_bf16 v[48:51], v[76:79], v[104:107], v[48:51]
    ds_read_b128 v[76:79], v2 offset:8192
    buffer_load_dwordx4 v[116:119], v2, s[32:35], s22 offen offset:0 sc1
    s_waitcnt lgkmcnt(5)
    v_mfma_f32_16x16x32_bf16 v[24:27], v[80:83], v[100:103], v[52:55]
    v_mfma_f32_16x16x32_bf16 v[52:55], v[80:83], v[104:107], v[52:55]
    ds_read_b128 v[80:83], v2 offset:9216
    v_mfma_f32_16x16x32_bf16 v[28:31], v[84:87], v[100:103], v[56:59]
    v_mfma_f32_16x16x32_bf16 v[56:59], v[84:87], v[104:107], v[56:59]
    ds_read_b128 v[84:87], v2 offset:10240
    buffer_load_dwordx4 v[120:123], v2, s[32:35], s22 offen offset:1024 sc1
    s_waitcnt lgkmcnt(5)
    v_mfma_f32_16x16x32_bf16 v[32:35], v[88:91], v[100:103], v[60:63]
    v_mfma_f32_16x16x32_bf16 v[60:63], v[88:91], v[104:107], v[60:63]
    ds_read_b128 v[88:91], v2 offset:11264
    v_mfma_f32_16x16x32_bf16 v[36:39], v[92:95], v[100:103], v[64:67]
    v_mfma_f32_16x16x32_bf16 v[64:67], v[92:95], v[104:107], v[64:67]
    ds_read_b128 v[92:95], v2 offset:12288
    buffer_load_dwordx4 v[124:127], v2, s[32:35], s15 offen offset:0 sc1
    s_waitcnt lgkmcnt(6)
    v_mfma_f32_16x16x32_bf16 v[40:43], v[96:99], v[100:103], v[68:71]
    v_mfma_f32_16x16x32_bf16 v[68:71], v[96:99], v[104:107], v[68:71]
    ds_read_b128 v[96:99], v2 offset:13312
    s_waitcnt vmcnt(3)
    s_waitcnt lgkmcnt(5)
    v_mfma_f32_16x16x32_bf16 v[16:19], v[72:75], v[108:111], v[16:19]
    v_mfma_f32_16x16x32_bf16 v[44:47], v[72:75], v[112:115], v[44:47]
    ds_read_b128 v[72:75], v2 offset:14336
    v_mfma_f32_16x16x32_bf16 v[20:23], v[76:79], v[108:111], v[20:23]
    v_mfma_f32_16x16x32_bf16 v[48:51], v[76:79], v[112:115], v[48:51]
    ds_read_b128 v[76:79], v2 offset:15360
    buffer_load_dwordx4 v[128:131], v2, s[32:35], s15 offen offset:2048 sc1
    s_waitcnt lgkmcnt(5)
    v_mfma_f32_16x16x32_bf16 v[24:27], v[80:83], v[108:111], v[24:27]
    v_mfma_f32_16x16x32_bf16 v[52:55], v[80:83], v[112:115], v[52:55]
    ds_read_b128 v[80:83], v2 offset:16384
    v_mfma_f32_16x16x32_bf16 v[28:31], v[84:87], v[108:111], v[28:31]
    v_mfma_f32_16x16x32_bf16 v[56:59], v[84:87], v[112:115], v[56:59]
    ds_read_b128 v[84:87], v2 offset:17408
    buffer_load_dwordx4 v[132:135], v2, s[32:35], s15 offen offset:1024 sc1
    s_waitcnt lgkmcnt(5)
    v_mfma_f32_16x16x32_bf16 v[32:35], v[88:91], v[108:111], v[32:35]
    v_mfma_f32_16x16x32_bf16 v[60:63], v[88:91], v[112:115], v[60:63]
    ds_read_b128 v[88:91], v2 offset:18432
    v_mfma_f32_16x16x32_bf16 v[36:39], v[92:95], v[108:111], v[36:39]
    v_mfma_f32_16x16x32_bf16 v[64:67], v[92:95], v[112:115], v[64:67]
    ds_read_b128 v[92:95], v2 offset:19456
    buffer_load_dwordx4 v[136:139], v2, s[32:35], s15 offen offset:3072 sc1
    s_waitcnt lgkmcnt(6)
    v_mfma_f32_16x16x32_bf16 v[40:43], v[96:99], v[108:111], v[40:43]
    v_mfma_f32_16x16x32_bf16 v[68:71], v[96:99], v[112:115], v[68:71]
    ds_read_b128 v[96:99], v2 offset:20480
    s_waitcnt vmcnt(4)
    s_waitcnt lgkmcnt(5)
    v_mfma_f32_16x16x32_bf16 v[16:19], v[72:75], v[116:119], v[16:19]
    v_mfma_f32_16x16x32_bf16 v[44:47], v[72:75], v[120:123], v[44:47]
    ds_read_b128 v[72:75], v2 offset:21504
    v_mfma_f32_16x16x32_bf16 v[20:23], v[76:79], v[116:119], v[20:23]
    v_mfma_f32_16x16x32_bf16 v[48:51], v[76:79], v[120:123], v[48:51]
    ds_read_b128 v[76:79], v2 offset:22528
    buffer_load_dwordx4 v[140:143], v2, s[32:35], s16 offen offset:0 sc1
    s_waitcnt lgkmcnt(5)
    v_mfma_f32_16x16x32_bf16 v[24:27], v[80:83], v[116:119], v[24:27]
    v_mfma_f32_16x16x32_bf16 v[52:55], v[80:83], v[120:123], v[52:55]
    ds_read_b128 v[80:83], v2 offset:23552
    v_mfma_f32_16x16x32_bf16 v[28:31], v[84:87], v[116:119], v[28:31]
    v_mfma_f32_16x16x32_bf16 v[56:59], v[84:87], v[120:123], v[56:59]
    ds_read_b128 v[84:87], v2 offset:24576
    buffer_load_dwordx4 v[144:147], v2, s[32:35], s16 offen offset:2048 sc1
    s_waitcnt lgkmcnt(5)
    v_mfma_f32_16x16x32_bf16 v[32:35], v[88:91], v[116:119], v[32:35]
    v_mfma_f32_16x16x32_bf16 v[60:63], v[88:91], v[120:123], v[60:63]
    ds_read_b128 v[88:91], v2 offset:25600
    v_mfma_f32_16x16x32_bf16 v[36:39], v[92:95], v[116:119], v[36:39]
    v_mfma_f32_16x16x32_bf16 v[64:67], v[92:95], v[120:123], v[64:67]
    ds_read_b128 v[92:95], v2 offset:26624
    buffer_load_dwordx4 v[148:151], v2, s[32:35], s16 offen offset:1024 sc1
    s_waitcnt lgkmcnt(6)
    v_mfma_f32_16x16x32_bf16 v[40:43], v[96:99], v[116:119], v[40:43]
    v_mfma_f32_16x16x32_bf16 v[68:71], v[96:99], v[120:123], v[68:71]
    ds_read_b128 v[96:99], v2 offset:27648
    s_waitcnt vmcnt(5)
    s_waitcnt lgkmcnt(5)
    v_mfma_f32_16x16x32_bf16 v[16:19], v[72:75], v[124:127], v[16:19]
    v_mfma_f32_16x16x32_bf16 v[44:47], v[72:75], v[128:131], v[44:47]
    ds_read_b128 v[72:75], v2 offset:28672
    v_mfma_f32_16x16x32_bf16 v[20:23], v[76:79], v[124:127], v[20:23]
    v_mfma_f32_16x16x32_bf16 v[48:51], v[76:79], v[128:131], v[48:51]
    ds_read_b128 v[76:79], v2 offset:29696
    buffer_load_dwordx4 v[152:155], v2, s[32:35], s16 offen offset:3072 sc1
    s_waitcnt lgkmcnt(5)
    v_mfma_f32_16x16x32_bf16 v[24:27], v[80:83], v[124:127], v[24:27]
    v_mfma_f32_16x16x32_bf16 v[52:55], v[80:83], v[128:131], v[52:55]
    ds_read_b128 v[80:83], v2 offset:30720
    v_mfma_f32_16x16x32_bf16 v[28:31], v[84:87], v[124:127], v[28:31]
    v_mfma_f32_16x16x32_bf16 v[56:59], v[84:87], v[128:131], v[56:59]
    ds_read_b128 v[84:87], v2 offset:31744
    buffer_load_dwordx4 v[156:159], v2, s[32:35], s23 offen offset:0 sc1
    s_waitcnt lgkmcnt(5)
    v_mfma_f32_16x16x32_bf16 v[32:35], v[88:91], v[124:127], v[32:35]
    v_mfma_f32_16x16x32_bf16 v[60:63], v[88:91], v[128:131], v[60:63]
    ds_read_b128 v[88:91], v2 offset:32768
    v_mfma_f32_16x16x32_bf16 v[36:39], v[92:95], v[124:127], v[36:39]
    v_mfma_f32_16x16x32_bf16 v[64:67], v[92:95], v[128:131], v[64:67]
    ds_read_b128 v[92:95], v2 offset:33792
    buffer_load_dwordx4 v[160:163], v2, s[32:35], s23 offen offset:1024 sc1
    s_waitcnt lgkmcnt(6)
    v_mfma_f32_16x16x32_bf16 v[40:43], v[96:99], v[124:127], v[40:43]
    v_mfma_f32_16x16x32_bf16 v[68:71], v[96:99], v[128:131], v[68:71]
    ds_read_b128 v[96:99], v2 offset:34816
    s_waitcnt vmcnt(6)
    s_waitcnt lgkmcnt(5)
    v_mfma_f32_16x16x32_bf16 v[16:19], v[72:75], v[132:135], v[16:19]
    v_mfma_f32_16x16x32_bf16 v[44:47], v[72:75], v[136:139], v[44:47]
    ds_read_b128 v[72:75], v2 offset:35840
    v_mfma_f32_16x16x32_bf16 v[20:23], v[76:79], v[132:135], v[20:23]
    v_mfma_f32_16x16x32_bf16 v[48:51], v[76:79], v[136:139], v[48:51]
    ds_read_b128 v[76:79], v2 offset:36864
    buffer_load_dwordx4 v[164:167], v2, s[32:35], s17 offen offset:0 sc1
    s_waitcnt lgkmcnt(5)
    v_mfma_f32_16x16x32_bf16 v[24:27], v[80:83], v[132:135], v[24:27]
    v_mfma_f32_16x16x32_bf16 v[52:55], v[80:83], v[136:139], v[52:55]
    ds_read_b128 v[80:83], v2 offset:37888
    v_mfma_f32_16x16x32_bf16 v[28:31], v[84:87], v[132:135], v[28:31]
    v_mfma_f32_16x16x32_bf16 v[56:59], v[84:87], v[136:139], v[56:59]
    ds_read_b128 v[84:87], v2 offset:38912
    buffer_load_dwordx4 v[168:171], v2, s[32:35], s17 offen offset:2048 sc1
    s_waitcnt lgkmcnt(5)
    v_mfma_f32_16x16x32_bf16 v[32:35], v[88:91], v[132:135], v[32:35]
    v_mfma_f32_16x16x32_bf16 v[60:63], v[88:91], v[136:139], v[60:63]
    ds_read_b128 v[88:91], v2 offset:39936
    v_mfma_f32_16x16x32_bf16 v[36:39], v[92:95], v[132:135], v[36:39]
    v_mfma_f32_16x16x32_bf16 v[64:67], v[92:95], v[136:139], v[64:67]
    ds_read_b128 v[92:95], v2 offset:40960
    buffer_load_dwordx4 v[172:175], v2, s[32:35], s17 offen offset:1024 sc1
    s_waitcnt lgkmcnt(6)
    v_mfma_f32_16x16x32_bf16 v[40:43], v[96:99], v[132:135], v[40:43]
    v_mfma_f32_16x16x32_bf16 v[68:71], v[96:99], v[136:139], v[68:71]
    ds_read_b128 v[96:99], v2 offset:41984
    s_waitcnt vmcnt(7)
    s_waitcnt lgkmcnt(5)
    v_mfma_f32_16x16x32_bf16 v[16:19], v[72:75], v[140:143], v[16:19]
    v_mfma_f32_16x16x32_bf16 v[44:47], v[72:75], v[144:147], v[44:47]
    ds_read_b128 v[72:75], v2 offset:43008
    v_mfma_f32_16x16x32_bf16 v[20:23], v[76:79], v[140:143], v[20:23]
    v_mfma_f32_16x16x32_bf16 v[48:51], v[76:79], v[144:147], v[48:51]
    ds_read_b128 v[76:79], v2 offset:44032
    buffer_load_dwordx4 v[176:179], v2, s[32:35], s17 offen offset:3072 sc1
    s_waitcnt lgkmcnt(5)
    v_mfma_f32_16x16x32_bf16 v[24:27], v[80:83], v[140:143], v[24:27]
    v_mfma_f32_16x16x32_bf16 v[52:55], v[80:83], v[144:147], v[52:55]
    ds_read_b128 v[80:83], v2 offset:45056
    v_mfma_f32_16x16x32_bf16 v[28:31], v[84:87], v[140:143], v[28:31]
    v_mfma_f32_16x16x32_bf16 v[56:59], v[84:87], v[144:147], v[56:59]
    ds_read_b128 v[84:87], v2 offset:46080
    buffer_load_dwordx4 v[100:103], v2, s[32:35], s18 offen offset:0 sc1
    s_waitcnt lgkmcnt(5)
    v_mfma_f32_16x16x32_bf16 v[32:35], v[88:91], v[140:143], v[32:35]
    v_mfma_f32_16x16x32_bf16 v[60:63], v[88:91], v[144:147], v[60:63]
    ds_read_b128 v[88:91], v2 offset:47104
    v_mfma_f32_16x16x32_bf16 v[36:39], v[92:95], v[140:143], v[36:39]
    v_mfma_f32_16x16x32_bf16 v[64:67], v[92:95], v[144:147], v[64:67]
    ds_read_b128 v[92:95], v2 offset:48128
    buffer_load_dwordx4 v[104:107], v2, s[32:35], s18 offen offset:2048 sc1
    s_waitcnt lgkmcnt(6)
    v_mfma_f32_16x16x32_bf16 v[40:43], v[96:99], v[140:143], v[40:43]
    v_mfma_f32_16x16x32_bf16 v[68:71], v[96:99], v[144:147], v[68:71]
    ds_read_b128 v[96:99], v2 offset:49152
    s_waitcnt vmcnt(8)
    s_waitcnt lgkmcnt(5)
    v_mfma_f32_16x16x32_bf16 v[16:19], v[72:75], v[148:151], v[16:19]
    v_mfma_f32_16x16x32_bf16 v[44:47], v[72:75], v[152:155], v[44:47]
    ds_read_b128 v[72:75], v2 offset:50176
    v_mfma_f32_16x16x32_bf16 v[20:23], v[76:79], v[148:151], v[20:23]
    v_mfma_f32_16x16x32_bf16 v[48:51], v[76:79], v[152:155], v[48:51]
    ds_read_b128 v[76:79], v2 offset:51200
    buffer_load_dwordx4 v[108:111], v2, s[32:35], s18 offen offset:1024 sc1
    s_waitcnt lgkmcnt(5)
    v_mfma_f32_16x16x32_bf16 v[24:27], v[80:83], v[148:151], v[24:27]
    v_mfma_f32_16x16x32_bf16 v[52:55], v[80:83], v[152:155], v[52:55]
    ds_read_b128 v[80:83], v2 offset:52224
    v_mfma_f32_16x16x32_bf16 v[28:31], v[84:87], v[148:151], v[28:31]
    v_mfma_f32_16x16x32_bf16 v[56:59], v[84:87], v[152:155], v[56:59]
    ds_read_b128 v[84:87], v2 offset:53248
    buffer_load_dwordx4 v[112:115], v2, s[32:35], s18 offen offset:3072 sc1
    s_waitcnt lgkmcnt(5)
    v_mfma_f32_16x16x32_bf16 v[32:35], v[88:91], v[148:151], v[32:35]
    v_mfma_f32_16x16x32_bf16 v[60:63], v[88:91], v[152:155], v[60:63]
    ds_read_b128 v[88:91], v2 offset:54272
    v_mfma_f32_16x16x32_bf16 v[36:39], v[92:95], v[148:151], v[36:39]
    v_mfma_f32_16x16x32_bf16 v[64:67], v[92:95], v[152:155], v[64:67]
    ds_read_b128 v[92:95], v2 offset:55296
    buffer_load_dwordx4 v[116:119], v2, s[32:35], s64 offen offset:0 sc1
    s_waitcnt lgkmcnt(6)
    v_mfma_f32_16x16x32_bf16 v[40:43], v[96:99], v[148:151], v[40:43]
    v_mfma_f32_16x16x32_bf16 v[68:71], v[96:99], v[152:155], v[68:71]
    ds_read_b128 v[96:99], v2 offset:56320
    s_waitcnt vmcnt(9)
    s_waitcnt lgkmcnt(5)
    v_mfma_f32_16x16x32_bf16 v[16:19], v[72:75], v[156:159], v[16:19]
    v_mfma_f32_16x16x32_bf16 v[44:47], v[72:75], v[160:163], v[44:47]
    ds_read_b128 v[72:75], v2 offset:57344
    v_mfma_f32_16x16x32_bf16 v[20:23], v[76:79], v[156:159], v[20:23]
    v_mfma_f32_16x16x32_bf16 v[48:51], v[76:79], v[160:163], v[48:51]
    ds_read_b128 v[76:79], v2 offset:58368
    buffer_load_dwordx4 v[120:123], v2, s[32:35], s64 offen offset:1024 sc1
    s_waitcnt lgkmcnt(5)
    v_mfma_f32_16x16x32_bf16 v[24:27], v[80:83], v[156:159], v[24:27]
    v_mfma_f32_16x16x32_bf16 v[52:55], v[80:83], v[160:163], v[52:55]
    ds_read_b128 v[80:83], v2 offset:59392
    v_mfma_f32_16x16x32_bf16 v[28:31], v[84:87], v[156:159], v[28:31]
    v_mfma_f32_16x16x32_bf16 v[56:59], v[84:87], v[160:163], v[56:59]
    ds_read_b128 v[84:87], v2 offset:60416
    buffer_load_dwordx4 v[124:127], v2, s[32:35], s19 offen offset:0 sc1
    s_waitcnt lgkmcnt(5)
    v_mfma_f32_16x16x32_bf16 v[32:35], v[88:91], v[156:159], v[32:35]
    v_mfma_f32_16x16x32_bf16 v[60:63], v[88:91], v[160:163], v[60:63]
    ds_read_b128 v[88:91], v2 offset:61440
    v_mfma_f32_16x16x32_bf16 v[36:39], v[92:95], v[156:159], v[36:39]
    v_mfma_f32_16x16x32_bf16 v[64:67], v[92:95], v[160:163], v[64:67]
    ds_read_b128 v[92:95], v2 offset:62464
    buffer_load_dwordx4 v[128:131], v2, s[32:35], s19 offen offset:2048 sc1
    s_waitcnt lgkmcnt(6)
    v_mfma_f32_16x16x32_bf16 v[40:43], v[96:99], v[156:159], v[40:43]
    v_mfma_f32_16x16x32_bf16 v[68:71], v[96:99], v[160:163], v[68:71]
    ds_read_b128 v[96:99], v2 offset:63488
    s_waitcnt vmcnt(10)
    s_waitcnt lgkmcnt(5)
    v_mfma_f32_16x16x32_bf16 v[16:19], v[72:75], v[164:167], v[16:19]
    v_mfma_f32_16x16x32_bf16 v[44:47], v[72:75], v[168:171], v[44:47]
    ds_read_b128 v[72:75], v4 offset:0
    v_mfma_f32_16x16x32_bf16 v[20:23], v[76:79], v[164:167], v[20:23]
    v_mfma_f32_16x16x32_bf16 v[48:51], v[76:79], v[168:171], v[48:51]
    ds_read_b128 v[76:79], v4 offset:1024
    buffer_load_dwordx4 v[132:135], v2, s[32:35], s19 offen offset:1024 sc1
    s_waitcnt lgkmcnt(5)
    v_mfma_f32_16x16x32_bf16 v[24:27], v[80:83], v[164:167], v[24:27]
    v_mfma_f32_16x16x32_bf16 v[52:55], v[80:83], v[168:171], v[52:55]
    ds_read_b128 v[80:83], v4 offset:2048
    v_mfma_f32_16x16x32_bf16 v[28:31], v[84:87], v[164:167], v[28:31]
    v_mfma_f32_16x16x32_bf16 v[56:59], v[84:87], v[168:171], v[56:59]
    ds_read_b128 v[84:87], v4 offset:3072
    buffer_load_dwordx4 v[136:139], v2, s[32:35], s19 offen offset:3072 sc1
    s_waitcnt lgkmcnt(5)
    v_mfma_f32_16x16x32_bf16 v[32:35], v[88:91], v[164:167], v[32:35]
    v_mfma_f32_16x16x32_bf16 v[60:63], v[88:91], v[168:171], v[60:63]
    ds_read_b128 v[88:91], v4 offset:4096
    v_mfma_f32_16x16x32_bf16 v[36:39], v[92:95], v[164:167], v[36:39]
    v_mfma_f32_16x16x32_bf16 v[64:67], v[92:95], v[168:171], v[64:67]
    ds_read_b128 v[92:95], v4 offset:5120
    buffer_load_dwordx4 v[140:143], v2, s[32:35], s20 offen offset:0 sc1
    s_waitcnt lgkmcnt(6)
    v_mfma_f32_16x16x32_bf16 v[40:43], v[96:99], v[164:167], v[40:43]
    v_mfma_f32_16x16x32_bf16 v[68:71], v[96:99], v[168:171], v[68:71]
    ds_read_b128 v[96:99], v4 offset:6144
    s_waitcnt vmcnt(11)
    s_waitcnt lgkmcnt(5)
    v_mfma_f32_16x16x32_bf16 v[16:19], v[72:75], v[172:175], v[16:19]
    v_mfma_f32_16x16x32_bf16 v[44:47], v[72:75], v[176:179], v[44:47]
    ds_read_b128 v[72:75], v4 offset:7168
    v_mfma_f32_16x16x32_bf16 v[20:23], v[76:79], v[172:175], v[20:23]
    v_mfma_f32_16x16x32_bf16 v[48:51], v[76:79], v[176:179], v[48:51]
    ds_read_b128 v[76:79], v4 offset:8192
    buffer_load_dwordx4 v[144:147], v2, s[32:35], s20 offen offset:2048 sc1
    s_waitcnt lgkmcnt(5)
    v_mfma_f32_16x16x32_bf16 v[24:27], v[80:83], v[172:175], v[24:27]
    v_mfma_f32_16x16x32_bf16 v[52:55], v[80:83], v[176:179], v[52:55]
    ds_read_b128 v[80:83], v4 offset:9216
    v_mfma_f32_16x16x32_bf16 v[28:31], v[84:87], v[172:175], v[28:31]
    v_mfma_f32_16x16x32_bf16 v[56:59], v[84:87], v[176:179], v[56:59]
    ds_read_b128 v[84:87], v4 offset:10240
    buffer_load_dwordx4 v[148:151], v2, s[32:35], s20 offen offset:1024 sc1
    s_waitcnt lgkmcnt(5)
    v_mfma_f32_16x16x32_bf16 v[32:35], v[88:91], v[172:175], v[32:35]
    v_mfma_f32_16x16x32_bf16 v[60:63], v[88:91], v[176:179], v[60:63]
    ds_read_b128 v[88:91], v4 offset:11264
    v_mfma_f32_16x16x32_bf16 v[36:39], v[92:95], v[172:175], v[36:39]
    v_mfma_f32_16x16x32_bf16 v[64:67], v[92:95], v[176:179], v[64:67]
    ds_read_b128 v[92:95], v4 offset:12288
    buffer_load_dwordx4 v[152:155], v2, s[32:35], s20 offen offset:3072 sc1
    s_waitcnt lgkmcnt(6)
    v_mfma_f32_16x16x32_bf16 v[40:43], v[96:99], v[172:175], v[40:43]
    v_mfma_f32_16x16x32_bf16 v[68:71], v[96:99], v[176:179], v[68:71]
    ds_read_b128 v[96:99], v4 offset:13312
    s_waitcnt vmcnt(12)
    s_waitcnt lgkmcnt(5)
    v_mfma_f32_16x16x32_bf16 v[16:19], v[72:75], v[100:103], v[16:19]
    v_mfma_f32_16x16x32_bf16 v[44:47], v[72:75], v[104:107], v[44:47]
    ds_read_b128 v[72:75], v4 offset:14336
    v_mfma_f32_16x16x32_bf16 v[20:23], v[76:79], v[100:103], v[20:23]
    v_mfma_f32_16x16x32_bf16 v[48:51], v[76:79], v[104:107], v[48:51]
    ds_read_b128 v[76:79], v4 offset:15360
    buffer_load_dwordx4 v[156:159], v2, s[32:35], s65 offen offset:0 sc1
    s_waitcnt lgkmcnt(5)
    v_mfma_f32_16x16x32_bf16 v[24:27], v[80:83], v[100:103], v[24:27]
    v_mfma_f32_16x16x32_bf16 v[52:55], v[80:83], v[104:107], v[52:55]
    ds_read_b128 v[80:83], v4 offset:16384
    v_mfma_f32_16x16x32_bf16 v[28:31], v[84:87], v[100:103], v[28:31]
    v_mfma_f32_16x16x32_bf16 v[56:59], v[84:87], v[104:107], v[56:59]
    ds_read_b128 v[84:87], v4 offset:17408
    buffer_load_dwordx4 v[160:163], v2, s[32:35], s65 offen offset:1024 sc1
    s_waitcnt lgkmcnt(5)
    v_mfma_f32_16x16x32_bf16 v[32:35], v[88:91], v[100:103], v[32:35]
    v_mfma_f32_16x16x32_bf16 v[60:63], v[88:91], v[104:107], v[60:63]
    ds_read_b128 v[88:91], v4 offset:18432
    v_mfma_f32_16x16x32_bf16 v[36:39], v[92:95], v[100:103], v[36:39]
    v_mfma_f32_16x16x32_bf16 v[64:67], v[92:95], v[104:107], v[64:67]
    ds_read_b128 v[92:95], v4 offset:19456
    buffer_load_dwordx4 v[164:167], v2, s[32:35], s21 offen offset:0 sc1
    s_waitcnt lgkmcnt(6)
    v_mfma_f32_16x16x32_bf16 v[40:43], v[96:99], v[100:103], v[40:43]
    v_mfma_f32_16x16x32_bf16 v[68:71], v[96:99], v[104:107], v[68:71]
    ds_read_b128 v[96:99], v4 offset:20480
    s_waitcnt vmcnt(13)
    s_waitcnt lgkmcnt(5)
    v_mfma_f32_16x16x32_bf16 v[16:19], v[72:75], v[108:111], v[16:19]
    v_mfma_f32_16x16x32_bf16 v[44:47], v[72:75], v[112:115], v[44:47]
    ds_read_b128 v[72:75], v4 offset:21504
    v_mfma_f32_16x16x32_bf16 v[20:23], v[76:79], v[108:111], v[20:23]
    v_mfma_f32_16x16x32_bf16 v[48:51], v[76:79], v[112:115], v[48:51]
    ds_read_b128 v[76:79], v4 offset:22528
    buffer_load_dwordx4 v[168:171], v2, s[32:35], s21 offen offset:2048 sc1
    s_waitcnt lgkmcnt(5)
    v_mfma_f32_16x16x32_bf16 v[24:27], v[80:83], v[108:111], v[24:27]
    v_mfma_f32_16x16x32_bf16 v[52:55], v[80:83], v[112:115], v[52:55]
    ds_read_b128 v[80:83], v4 offset:23552
    v_mfma_f32_16x16x32_bf16 v[28:31], v[84:87], v[108:111], v[28:31]
    v_mfma_f32_16x16x32_bf16 v[56:59], v[84:87], v[112:115], v[56:59]
    ds_read_b128 v[84:87], v4 offset:24576
    buffer_load_dwordx4 v[172:175], v2, s[32:35], s21 offen offset:1024 sc1
    s_waitcnt lgkmcnt(5)
    v_mfma_f32_16x16x32_bf16 v[32:35], v[88:91], v[108:111], v[32:35]
    v_mfma_f32_16x16x32_bf16 v[60:63], v[88:91], v[112:115], v[60:63]
    ds_read_b128 v[88:91], v4 offset:25600
    v_mfma_f32_16x16x32_bf16 v[36:39], v[92:95], v[108:111], v[36:39]
    v_mfma_f32_16x16x32_bf16 v[64:67], v[92:95], v[112:115], v[64:67]
    ds_read_b128 v[92:95], v4 offset:26624
    buffer_load_dwordx4 v[176:179], v2, s[32:35], s21 offen offset:3072 sc1
    s_waitcnt lgkmcnt(6)
    v_mfma_f32_16x16x32_bf16 v[40:43], v[96:99], v[108:111], v[40:43]
    v_mfma_f32_16x16x32_bf16 v[68:71], v[96:99], v[112:115], v[68:71]
    ds_read_b128 v[96:99], v4 offset:27648
    s_waitcnt vmcnt(14)
    s_waitcnt lgkmcnt(5)
    v_mfma_f32_16x16x32_bf16 v[16:19], v[72:75], v[116:119], v[16:19]
    v_mfma_f32_16x16x32_bf16 v[44:47], v[72:75], v[120:123], v[44:47]
    ds_read_b128 v[72:75], v4 offset:28672
    v_mfma_f32_16x16x32_bf16 v[20:23], v[76:79], v[116:119], v[20:23]
    v_mfma_f32_16x16x32_bf16 v[48:51], v[76:79], v[120:123], v[48:51]
    ds_read_b128 v[76:79], v4 offset:29696
    s_waitcnt lgkmcnt(5)
    v_mfma_f32_16x16x32_bf16 v[24:27], v[80:83], v[116:119], v[24:27]
    v_mfma_f32_16x16x32_bf16 v[52:55], v[80:83], v[120:123], v[52:55]
    ds_read_b128 v[80:83], v4 offset:30720
    v_mfma_f32_16x16x32_bf16 v[28:31], v[84:87], v[116:119], v[28:31]
    v_mfma_f32_16x16x32_bf16 v[56:59], v[84:87], v[120:123], v[56:59]
    ds_read_b128 v[84:87], v4 offset:31744
    s_waitcnt lgkmcnt(5)
    v_mfma_f32_16x16x32_bf16 v[32:35], v[88:91], v[116:119], v[32:35]
    v_mfma_f32_16x16x32_bf16 v[60:63], v[88:91], v[120:123], v[60:63]
    ds_read_b128 v[88:91], v4 offset:32768
    v_mfma_f32_16x16x32_bf16 v[36:39], v[92:95], v[116:119], v[36:39]
    v_mfma_f32_16x16x32_bf16 v[64:67], v[92:95], v[120:123], v[64:67]
    ds_read_b128 v[92:95], v4 offset:33792
    s_waitcnt lgkmcnt(6)
    v_mfma_f32_16x16x32_bf16 v[40:43], v[96:99], v[116:119], v[40:43]
    v_mfma_f32_16x16x32_bf16 v[68:71], v[96:99], v[120:123], v[68:71]
    ds_read_b128 v[96:99], v4 offset:34816
    s_waitcnt vmcnt(12)
    s_waitcnt lgkmcnt(5)
    v_mfma_f32_16x16x32_bf16 v[16:19], v[72:75], v[124:127], v[16:19]
    v_mfma_f32_16x16x32_bf16 v[44:47], v[72:75], v[128:131], v[44:47]
    ds_read_b128 v[72:75], v4 offset:35840
    v_mfma_f32_16x16x32_bf16 v[20:23], v[76:79], v[124:127], v[20:23]
    v_mfma_f32_16x16x32_bf16 v[48:51], v[76:79], v[128:131], v[48:51]
    ds_read_b128 v[76:79], v4 offset:36864
    s_waitcnt lgkmcnt(5)
    v_mfma_f32_16x16x32_bf16 v[24:27], v[80:83], v[124:127], v[24:27]
    v_mfma_f32_16x16x32_bf16 v[52:55], v[80:83], v[128:131], v[52:55]
    ds_read_b128 v[80:83], v4 offset:37888
    v_mfma_f32_16x16x32_bf16 v[28:31], v[84:87], v[124:127], v[28:31]
    v_mfma_f32_16x16x32_bf16 v[56:59], v[84:87], v[128:131], v[56:59]
    ds_read_b128 v[84:87], v4 offset:38912
    s_waitcnt lgkmcnt(5)
    v_mfma_f32_16x16x32_bf16 v[32:35], v[88:91], v[124:127], v[32:35]
    v_mfma_f32_16x16x32_bf16 v[60:63], v[88:91], v[128:131], v[60:63]
    ds_read_b128 v[88:91], v4 offset:39936
    v_mfma_f32_16x16x32_bf16 v[36:39], v[92:95], v[124:127], v[36:39]
    v_mfma_f32_16x16x32_bf16 v[64:67], v[92:95], v[128:131], v[64:67]
    ds_read_b128 v[92:95], v4 offset:40960
    s_waitcnt lgkmcnt(6)
    v_mfma_f32_16x16x32_bf16 v[40:43], v[96:99], v[124:127], v[40:43]
    v_mfma_f32_16x16x32_bf16 v[68:71], v[96:99], v[128:131], v[68:71]
    ds_read_b128 v[96:99], v4 offset:41984
    s_waitcnt vmcnt(10)
    s_waitcnt lgkmcnt(5)
    v_mfma_f32_16x16x32_bf16 v[16:19], v[72:75], v[132:135], v[16:19]
    v_mfma_f32_16x16x32_bf16 v[44:47], v[72:75], v[136:139], v[44:47]
    ds_read_b128 v[72:75], v4 offset:43008
    v_mfma_f32_16x16x32_bf16 v[20:23], v[76:79], v[132:135], v[20:23]
    v_mfma_f32_16x16x32_bf16 v[48:51], v[76:79], v[136:139], v[48:51]
    ds_read_b128 v[76:79], v4 offset:44032
    s_waitcnt lgkmcnt(5)
    v_mfma_f32_16x16x32_bf16 v[24:27], v[80:83], v[132:135], v[24:27]
    v_mfma_f32_16x16x32_bf16 v[52:55], v[80:83], v[136:139], v[52:55]
    ds_read_b128 v[80:83], v4 offset:45056
    v_mfma_f32_16x16x32_bf16 v[28:31], v[84:87], v[132:135], v[28:31]
    v_mfma_f32_16x16x32_bf16 v[56:59], v[84:87], v[136:139], v[56:59]
    ds_read_b128 v[84:87], v4 offset:46080
    s_waitcnt lgkmcnt(5)
    v_mfma_f32_16x16x32_bf16 v[32:35], v[88:91], v[132:135], v[32:35]
    v_mfma_f32_16x16x32_bf16 v[60:63], v[88:91], v[136:139], v[60:63]
    ds_read_b128 v[88:91], v4 offset:47104
    v_mfma_f32_16x16x32_bf16 v[36:39], v[92:95], v[132:135], v[36:39]
    v_mfma_f32_16x16x32_bf16 v[64:67], v[92:95], v[136:139], v[64:67]
    ds_read_b128 v[92:95], v4 offset:48128
    s_waitcnt lgkmcnt(6)
    v_mfma_f32_16x16x32_bf16 v[40:43], v[96:99], v[132:135], v[40:43]
    v_mfma_f32_16x16x32_bf16 v[68:71], v[96:99], v[136:139], v[68:71]
    ds_read_b128 v[96:99], v4 offset:49152
    s_waitcnt vmcnt(8)
    s_waitcnt lgkmcnt(5)
    v_mfma_f32_16x16x32_bf16 v[16:19], v[72:75], v[140:143], v[16:19]
    v_mfma_f32_16x16x32_bf16 v[44:47], v[72:75], v[144:147], v[44:47]
    ds_read_b128 v[72:75], v4 offset:50176
    v_mfma_f32_16x16x32_bf16 v[20:23], v[76:79], v[140:143], v[20:23]
    v_mfma_f32_16x16x32_bf16 v[48:51], v[76:79], v[144:147], v[48:51]
    ds_read_b128 v[76:79], v4 offset:51200
    s_waitcnt lgkmcnt(5)
    v_mfma_f32_16x16x32_bf16 v[24:27], v[80:83], v[140:143], v[24:27]
    v_mfma_f32_16x16x32_bf16 v[52:55], v[80:83], v[144:147], v[52:55]
    ds_read_b128 v[80:83], v4 offset:52224
    v_mfma_f32_16x16x32_bf16 v[28:31], v[84:87], v[140:143], v[28:31]
    v_mfma_f32_16x16x32_bf16 v[56:59], v[84:87], v[144:147], v[56:59]
    ds_read_b128 v[84:87], v4 offset:53248
    s_waitcnt lgkmcnt(5)
    v_mfma_f32_16x16x32_bf16 v[32:35], v[88:91], v[140:143], v[32:35]
    v_mfma_f32_16x16x32_bf16 v[60:63], v[88:91], v[144:147], v[60:63]
    ds_read_b128 v[88:91], v4 offset:54272
    v_mfma_f32_16x16x32_bf16 v[36:39], v[92:95], v[140:143], v[36:39]
    v_mfma_f32_16x16x32_bf16 v[64:67], v[92:95], v[144:147], v[64:67]
    ds_read_b128 v[92:95], v4 offset:55296
    s_waitcnt lgkmcnt(6)
    v_mfma_f32_16x16x32_bf16 v[40:43], v[96:99], v[140:143], v[40:43]
    v_mfma_f32_16x16x32_bf16 v[68:71], v[96:99], v[144:147], v[68:71]
    ds_read_b128 v[96:99], v4 offset:56320
    s_waitcnt vmcnt(6)
    s_waitcnt lgkmcnt(5)
    v_mfma_f32_16x16x32_bf16 v[16:19], v[72:75], v[148:151], v[16:19]
    v_mfma_f32_16x16x32_bf16 v[44:47], v[72:75], v[152:155], v[44:47]
    ds_read_b128 v[72:75], v4 offset:57344
    v_mfma_f32_16x16x32_bf16 v[20:23], v[76:79], v[148:151], v[20:23]
    v_mfma_f32_16x16x32_bf16 v[48:51], v[76:79], v[152:155], v[48:51]
    ds_read_b128 v[76:79], v4 offset:58368
    s_waitcnt lgkmcnt(5)
    v_mfma_f32_16x16x32_bf16 v[24:27], v[80:83], v[148:151], v[24:27]
    v_mfma_f32_16x16x32_bf16 v[52:55], v[80:83], v[152:155], v[52:55]
    ds_read_b128 v[80:83], v4 offset:59392
    v_mfma_f32_16x16x32_bf16 v[28:31], v[84:87], v[148:151], v[28:31]
    v_mfma_f32_16x16x32_bf16 v[56:59], v[84:87], v[152:155], v[56:59]
    ds_read_b128 v[84:87], v4 offset:60416
    s_waitcnt lgkmcnt(5)
    v_mfma_f32_16x16x32_bf16 v[32:35], v[88:91], v[148:151], v[32:35]
    v_mfma_f32_16x16x32_bf16 v[60:63], v[88:91], v[152:155], v[60:63]
    ds_read_b128 v[88:91], v4 offset:61440
    v_mfma_f32_16x16x32_bf16 v[36:39], v[92:95], v[148:151], v[36:39]
    v_mfma_f32_16x16x32_bf16 v[64:67], v[92:95], v[152:155], v[64:67]
    ds_read_b128 v[92:95], v4 offset:62464
    s_waitcnt lgkmcnt(6)
    v_mfma_f32_16x16x32_bf16 v[40:43], v[96:99], v[148:151], v[40:43]
    v_mfma_f32_16x16x32_bf16 v[68:71], v[96:99], v[152:155], v[68:71]
    ds_read_b128 v[96:99], v4 offset:63488
    s_waitcnt vmcnt(4)
    s_waitcnt lgkmcnt(5)
    v_mfma_f32_16x16x32_bf16 v[16:19], v[72:75], v[156:159], v[16:19]
    v_mfma_f32_16x16x32_bf16 v[44:47], v[72:75], v[160:163], v[44:47]
    ds_read_b128 v[72:75], v5 offset:0
    v_mfma_f32_16x16x32_bf16 v[20:23], v[76:79], v[156:159], v[20:23]
    v_mfma_f32_16x16x32_bf16 v[48:51], v[76:79], v[160:163], v[48:51]
    ds_read_b128 v[76:79], v5 offset:1024
    s_waitcnt lgkmcnt(5)
    v_mfma_f32_16x16x32_bf16 v[24:27], v[80:83], v[156:159], v[24:27]
    v_mfma_f32_16x16x32_bf16 v[52:55], v[80:83], v[160:163], v[52:55]
    ds_read_b128 v[80:83], v5 offset:2048
    v_mfma_f32_16x16x32_bf16 v[28:31], v[84:87], v[156:159], v[28:31]
    v_mfma_f32_16x16x32_bf16 v[56:59], v[84:87], v[160:163], v[56:59]
    ds_read_b128 v[84:87], v5 offset:3072
    s_waitcnt lgkmcnt(5)
    v_mfma_f32_16x16x32_bf16 v[32:35], v[88:91], v[156:159], v[32:35]
    v_mfma_f32_16x16x32_bf16 v[60:63], v[88:91], v[160:163], v[60:63]
    ds_read_b128 v[88:91], v5 offset:4096
    v_mfma_f32_16x16x32_bf16 v[36:39], v[92:95], v[156:159], v[36:39]
    v_mfma_f32_16x16x32_bf16 v[64:67], v[92:95], v[160:163], v[64:67]
    ds_read_b128 v[92:95], v5 offset:5120
    s_waitcnt lgkmcnt(6)
    v_mfma_f32_16x16x32_bf16 v[40:43], v[96:99], v[156:159], v[40:43]
    v_mfma_f32_16x16x32_bf16 v[68:71], v[96:99], v[160:163], v[68:71]
    ds_read_b128 v[96:99], v5 offset:6144
    s_waitcnt vmcnt(2)
    s_waitcnt lgkmcnt(5)
    v_mfma_f32_16x16x32_bf16 v[16:19], v[72:75], v[164:167], v[16:19]
    v_mfma_f32_16x16x32_bf16 v[44:47], v[72:75], v[168:171], v[44:47]
    ds_read_b128 v[72:75], v5 offset:7168
    v_mfma_f32_16x16x32_bf16 v[20:23], v[76:79], v[164:167], v[20:23]
    v_mfma_f32_16x16x32_bf16 v[48:51], v[76:79], v[168:171], v[48:51]
    ds_read_b128 v[76:79], v5 offset:8192
    s_waitcnt lgkmcnt(5)
    v_mfma_f32_16x16x32_bf16 v[24:27], v[80:83], v[164:167], v[24:27]
    v_mfma_f32_16x16x32_bf16 v[52:55], v[80:83], v[168:171], v[52:55]
    ds_read_b128 v[80:83], v5 offset:9216
    v_mfma_f32_16x16x32_bf16 v[28:31], v[84:87], v[164:167], v[28:31]
    v_mfma_f32_16x16x32_bf16 v[56:59], v[84:87], v[168:171], v[56:59]
    ds_read_b128 v[84:87], v5 offset:10240
    s_waitcnt lgkmcnt(5)
    v_mfma_f32_16x16x32_bf16 v[32:35], v[88:91], v[164:167], v[32:35]
    v_mfma_f32_16x16x32_bf16 v[60:63], v[88:91], v[168:171], v[60:63]
    ds_read_b128 v[88:91], v5 offset:11264
    v_mfma_f32_16x16x32_bf16 v[36:39], v[92:95], v[164:167], v[36:39]
    v_mfma_f32_16x16x32_bf16 v[64:67], v[92:95], v[168:171], v[64:67]
    ds_read_b128 v[92:95], v5 offset:12288
    s_waitcnt lgkmcnt(6)
    v_mfma_f32_16x16x32_bf16 v[40:43], v[96:99], v[164:167], v[40:43]
    v_mfma_f32_16x16x32_bf16 v[68:71], v[96:99], v[168:171], v[68:71]
    ds_read_b128 v[96:99], v5 offset:13312
    s_waitcnt vmcnt(0)
    s_waitcnt lgkmcnt(5)
    v_mfma_f32_16x16x32_bf16 v[16:19], v[72:75], v[172:175], v[16:19]
    v_mfma_f32_16x16x32_bf16 v[44:47], v[72:75], v[176:179], v[44:47]
    v_mfma_f32_16x16x32_bf16 v[20:23], v[76:79], v[172:175], v[20:23]
    v_mfma_f32_16x16x32_bf16 v[48:51], v[76:79], v[176:179], v[48:51]
    s_waitcnt lgkmcnt(3)
    v_mfma_f32_16x16x32_bf16 v[24:27], v[80:83], v[172:175], v[24:27]
    v_mfma_f32_16x16x32_bf16 v[52:55], v[80:83], v[176:179], v[52:55]
    v_mfma_f32_16x16x32_bf16 v[28:31], v[84:87], v[172:175], v[28:31]
    v_mfma_f32_16x16x32_bf16 v[56:59], v[84:87], v[176:179], v[56:59]
    s_waitcnt lgkmcnt(1)
    v_mfma_f32_16x16x32_bf16 v[32:35], v[88:91], v[172:175], v[32:35]
    v_mfma_f32_16x16x32_bf16 v[60:63], v[88:91], v[176:179], v[60:63]
    v_mfma_f32_16x16x32_bf16 v[36:39], v[92:95], v[172:175], v[36:39]
    v_mfma_f32_16x16x32_bf16 v[64:67], v[92:95], v[176:179], v[64:67]
    s_waitcnt lgkmcnt(0)
    v_mfma_f32_16x16x32_bf16 v[40:43], v[96:99], v[172:175], v[40:43]
    v_mfma_f32_16x16x32_bf16 v[68:71], v[96:99], v[176:179], v[68:71]
L_g1e:
    s_bfm_b64 s[76:77], 16, 48
    v_exp_f32 v140, v16
    v_exp_f32 v141, v17
    v_exp_f32 v144, v18
    v_exp_f32 v145, v19
    v_pk_add_f32 v[142:143], v[140:141], 2.0 op_sel_hi:[1,0]
    v_pk_fma_f32 v[140:141], v[140:141], v[142:143], 2.0 op_sel_hi:[1,1,0]
    v_rcp_f32 v140, v140
    v_rcp_f32 v141, v141
    v_exp_f32 v148, v20
    v_exp_f32 v149, v21
    v_pk_add_f32 v[146:147], v[144:145], 2.0 op_sel_hi:[1,0]
    v_pk_fma_f32 v[144:145], v[144:145], v[146:147], 2.0 op_sel_hi:[1,1,0]
    v_rcp_f32 v144, v144
    v_rcp_f32 v145, v145
    v_pk_mul_f32 v[140:141], v[140:141], v[16:17]
    v_pk_fma_f32 v[140:141], v[140:141], -2.0, v[16:17] op_sel_hi:[1,0,1]
    v_cvt_pk_bf16_f32 v100, v140, v141
    v_exp_f32 v140, v22
    v_exp_f32 v141, v23
    v_pk_add_f32 v[150:151], v[148:149], 2.0 op_sel_hi:[1,0]
    v_pk_fma_f32 v[148:149], v[148:149], v[150:151], 2.0 op_sel_hi:[1,1,0]
    v_rcp_f32 v148, v148
    v_rcp_f32 v149, v149
    v_pk_mul_f32 v[144:145], v[144:145], v[18:19]
    v_pk_fma_f32 v[144:145], v[144:145], -2.0, v[18:19] op_sel_hi:[1,0,1]
    v_cvt_pk_bf16_f32 v101, v144, v145
    v_exp_f32 v144, v44
    v_exp_f32 v145, v45
    v_pk_add_f32 v[142:143], v[140:141], 2.0 op_sel_hi:[1,0]
    v_pk_fma_f32 v[140:141], v[140:141], v[142:143], 2.0 op_sel_hi:[1,1,0]
    v_rcp_f32 v140, v140
    v_rcp_f32 v141, v141
    v_pk_mul_f32 v[148:149], v[148:149], v[20:21]
    v_pk_fma_f32 v[148:149], v[148:149], -2.0, v[20:21] op_sel_hi:[1,0,1]
    v_cvt_pk_bf16_f32 v102, v148, v149
    v_exp_f32 v148, v46
    v_exp_f32 v149, v47
    v_pk_add_f32 v[146:147], v[144:145], 2.0 op_sel_hi:[1,0]
    v_pk_fma_f32 v[144:145], v[144:145], v[146:147], 2.0 op_sel_hi:[1,1,0]
    v_rcp_f32 v144, v144
    v_rcp_f32 v145, v145
    v_pk_mul_f32 v[140:141], v[140:141], v[22:23]
    v_pk_fma_f32 v[140:141], v[140:141], -2.0, v[22:23] op_sel_hi:[1,0,1]
    v_cvt_pk_bf16_f32 v103, v140, v141
    buffer_store_dwordx4 v[100:103], v2, s[32:35], s88 offen offset:0 sc1
    v_exp_f32 v140, v48
    v_exp_f32 v141, v49
    v_pk_add_f32 v[150:151], v[148:149], 2.0 op_sel_hi:[1,0]
    v_pk_fma_f32 v[148:149], v[148:149], v[150:151], 2.0 op_sel_hi:[1,1,0]
    v_rcp_f32 v148, v148
    v_rcp_f32 v149, v149
    v_pk_mul_f32 v[144:145], v[144:145], v[44:45]
    v_pk_fma_f32 v[144:145], v[144:145], -2.0, v[44:45] op_sel_hi:[1,0,1]
    v_cvt_pk_bf16_f32 v116, v144, v145
    v_exp_f32 v144, v50
    v_exp_f32 v145, v51
    v_pk_add_f32 v[142:143], v[140:141], 2.0 op_sel_hi:[1,0]
    v_pk_fma_f32 v[140:141], v[140:141], v[142:143], 2.0 op_sel_hi:[1,1,0]
    v_rcp_f32 v140, v140
    v_rcp_f32 v141, v141
    v_pk_mul_f32 v[148:149], v[148:149], v[46:47]
    v_pk_fma_f32 v[148:149], v[148:149], -2.0, v[46:47] op_sel_hi:[1,0,1]
    v_cvt_pk_bf16_f32 v117, v148, v149
    v_exp_f32 v148, v24
    v_exp_f32 v149, v25
    v_pk_add_f32 v[146:147], v[144:145], 2.0 op_sel_hi:[1,0]
    v_pk_fma_f32 v[144:145], v[144:145], v[146:147], 2.0 op_sel_hi:[1,1,0]
    v_rcp_f32 v144, v144
    v_rcp_f32 v145, v145
    v_pk_mul_f32 v[140:141], v[140:141], v[48:49]
    v_pk_fma_f32 v[140:141], v[140:141], -2.0, v[48:49] op_sel_hi:[1,0,1]
    v_cvt_pk_bf16_f32 v118, v140, v141
    v_exp_f32 v140, v26
    v_exp_f32 v141, v27
    v_pk_add_f32 v[150:151], v[148:149], 2.0 op_sel_hi:[1,0]
    v_pk_fma_f32 v[148:149], v[148:149], v[150:151], 2.0 op_sel_hi:[1,1,0]
    v_rcp_f32 v148, v148
    v_rcp_f32 v149, v149
    v_pk_mul_f32 v[144:145], v[144:145], v[50:51]
    v_pk_fma_f32 v[144:145], v[144:145], -2.0, v[50:51] op_sel_hi:[1,0,1]
    v_cvt_pk_bf16_f32 v119, v144, v145
    buffer_store_dwordx4 v[116:119], v2, s[32:35], s89 offen offset:0 sc1
    v_exp_f32 v144, v28
    v_exp_f32 v145, v29
    v_pk_add_f32 v[142:143], v[140:141], 2.0 op_sel_hi:[1,0]
    v_pk_fma_f32 v[140:141], v[140:141], v[142:143], 2.0 op_sel_hi:[1,1,0]
    v_rcp_f32 v140, v140
    v_rcp_f32 v141, v141
    v_pk_mul_f32 v[148:149], v[148:149], v[24:25]
    v_pk_fma_f32 v[148:149], v[148:149], -2.0, v[24:25] op_sel_hi:[1,0,1]
    v_cvt_pk_bf16_f32 v104, v148, v149
    v_exp_f32 v148, v30
    v_exp_f32 v149, v31
    v_pk_add_f32 v[146:147], v[144:145], 2.0 op_sel_hi:[1,0]
    v_pk_fma_f32 v[144:145], v[144:145], v[146:147], 2.0 op_sel_hi:[1,1,0]
    v_rcp_f32 v144, v144
    v_rcp_f32 v145, v145
    v_pk_mul_f32 v[140:141], v[140:141], v[26:27]
    v_pk_fma_f32 v[140:141], v[140:141], -2.0, v[26:27] op_sel_hi:[1,0,1]
    v_cvt_pk_bf16_f32 v105, v140, v141
    v_exp_f32 v140, v52
    v_exp_f32 v141, v53
    v_pk_add_f32 v[150:151], v[148:149], 2.0 op_sel_hi:[1,0]
    v_pk_fma_f32 v[148:149], v[148:149], v[150:151], 2.0 op_sel_hi:[1,1,0]
    v_rcp_f32 v148, v148
    v_rcp_f32 v149, v149
    v_pk_mul_f32 v[144:145], v[144:145], v[28:29]
    v_pk_fma_f32 v[144:145], v[144:145], -2.0, v[28:29] op_sel_hi:[1,0,1]
    v_cvt_pk_bf16_f32 v106, v144, v145
    v_exp_f32 v144, v54
    v_exp_f32 v145, v55
    v_pk_add_f32 v[142:143], v[140:141], 2.0 op_sel_hi:[1,0]
    v_pk_fma_f32 v[140:141], v[140:141], v[142:143], 2.0 op_sel_hi:[1,1,0]
    v_rcp_f32 v140, v140
    v_rcp_f32 v141, v141
    v_pk_mul_f32 v[148:149], v[148:149], v[30:31]
    v_pk_fma_f32 v[148:149], v[148:149], -2.0, v[30:31] op_sel_hi:[1,0,1]
    v_cvt_pk_bf16_f32 v107, v148, v149
    buffer_store_dwordx4 v[104:107], v2, s[32:35], s88 offen offset:1024 sc1
    v_exp_f32 v148, v56
    v_exp_f32 v149, v57
    v_pk_add_f32 v[146:147], v[144:145], 2.0 op_sel_hi:[1,0]
    v_pk_fma_f32 v[144:145], v[144:145], v[146:147], 2.0 op_sel_hi:[1,1,0]
    v_rcp_f32 v144, v144
    v_rcp_f32 v145, v145
    v_pk_mul_f32 v[140:141], v[140:141], v[52:53]
    v_pk_fma_f32 v[140:141], v[140:141], -2.0, v[52:53] op_sel_hi:[1,0,1]
    v_cvt_pk_bf16_f32 v120, v140, v141
    v_exp_f32 v140, v58
    v_exp_f32 v141, v59
    v_pk_add_f32 v[150:151], v[148:149], 2.0 op_sel_hi:[1,0]
    v_pk_fma_f32 v[148:149], v[148:149], v[150:151], 2.0 op_sel_hi:[1,1,0]
    v_rcp_f32 v148, v148
    v_rcp_f32 v149, v149
    v_pk_mul_f32 v[144:145], v[144:145], v[54:55]
    v_pk_fma_f32 v[144:145], v[144:145], -2.0, v[54:55] op_sel_hi:[1,0,1]
    v_cvt_pk_bf16_f32 v121, v144, v145
    v_exp_f32 v144, v32
    v_exp_f32 v145, v33
    v_pk_add_f32 v[142:143], v[140:141], 2.0 op_sel_hi:[1,0]
    v_pk_fma_f32 v[140:141], v[140:141], v[142:143], 2.0 op_sel_hi:[1,1,0]
    v_rcp_f32 v140, v140
    v_rcp_f32 v141, v141
    v_pk_mul_f32 v[148:149], v[148:149], v[56:57]
    v_pk_fma_f32 v[148:149], v[148:149], -2.0, v[56:57] op_sel_hi:[1,0,1]
    v_cvt_pk_bf16_f32 v122, v148, v149
    v_exp_f32 v148, v34
    v_exp_f32 v149, v35
    v_pk_add_f32 v[146:147], v[144:145], 2.0 op_sel_hi:[1,0]
    v_pk_fma_f32 v[144:145], v[144:145], v[146:147], 2.0 op_sel_hi:[1,1,0]
    v_rcp_f32 v144, v144
    v_rcp_f32 v145, v145
    v_pk_mul_f32 v[140:141], v[140:141], v[58:59]
    v_pk_fma_f32 v[140:141], v[140:141], -2.0, v[58:59] op_sel_hi:[1,0,1]
    v_cvt_pk_bf16_f32 v123, v140, v141
    buffer_store_dwordx4 v[120:123], v2, s[32:35], s89 offen offset:1024 sc1
    v_exp_f32 v140, v36
    v_exp_f32 v141, v37
    v_pk_add_f32 v[150:151], v[148:149], 2.0 op_sel_hi:[1,0]
    v_pk_fma_f32 v[148:149], v[148:149], v[150:151], 2.0 op_sel_hi:[1,1,0]
    v_rcp_f32 v148, v148
    v_rcp_f32 v149, v149
    v_pk_mul_f32 v[144:145], v[144:145], v[32:33]
    v_pk_fma_f32 v[144:145], v[144:145], -2.0, v[32:33] op_sel_hi:[1,0,1]
    v_cvt_pk_bf16_f32 v108, v144, v145
    v_exp_f32 v144, v38
    v_exp_f32 v145, v39
    v_pk_add_f32 v[142:143], v[140:141], 2.0 op_sel_hi:[1,0]
    v_pk_fma_f32 v[140:141], v[140:141], v[142:143], 2.0 op_sel_hi:[1,1,0]
    v_rcp_f32 v140, v140
    v_rcp_f32 v141, v141
    v_pk_mul_f32 v[148:149], v[148:149], v[34:35]
    v_pk_fma_f32 v[148:149], v[148:149], -2.0, v[34:35] op_sel_hi:[1,0,1]
    v_cvt_pk_bf16_f32 v109, v148, v149
    v_exp_f32 v148, v60
    v_exp_f32 v149, v61
    v_pk_add_f32 v[146:147], v[144:145], 2.0 op_sel_hi:[1,0]
    v_pk_fma_f32 v[144:145], v[144:145], v[146:147], 2.0 op_sel_hi:[1,1,0]
    v_rcp_f32 v144, v144
    v_rcp_f32 v145, v145
    v_pk_mul_f32 v[140:141], v[140:141], v[36:37]
    v_pk_fma_f32 v[140:141], v[140:141], -2.0, v[36:37] op_sel_hi:[1,0,1]
    v_cvt_pk_bf16_f32 v110, v140, v141
    v_exp_f32 v140, v62
    v_exp_f32 v141, v63
    v_pk_add_f32 v[150:151], v[148:149], 2.0 op_sel_hi:[1,0]
    v_pk_fma_f32 v[148:149], v[148:149], v[150:151], 2.0 op_sel_hi:[1,1,0]
    v_rcp_f32 v148, v148
    v_rcp_f32 v149, v149
    v_pk_mul_f32 v[144:145], v[144:145], v[38:39]
    v_pk_fma_f32 v[144:145], v[144:145], -2.0, v[38:39] op_sel_hi:[1,0,1]
    v_cvt_pk_bf16_f32 v111, v144, v145
    buffer_store_dwordx4 v[108:111], v2, s[32:35], s88 offen offset:2048 sc1
    v_exp_f32 v144, v64
    v_exp_f32 v145, v65
    v_pk_add_f32 v[142:143], v[140:141], 2.0 op_sel_hi:[1,0]
    v_pk_fma_f32 v[140:141], v[140:141], v[142:143], 2.0 op_sel_hi:[1,1,0]
    v_rcp_f32 v140, v140
    v_rcp_f32 v141, v141
    v_pk_mul_f32 v[148:149], v[148:149], v[60:61]
    v_pk_fma_f32 v[148:149], v[148:149], -2.0, v[60:61] op_sel_hi:[1,0,1]
    v_cvt_pk_bf16_f32 v124, v148, v149
    v_exp_f32 v148, v66
    v_exp_f32 v149, v67
    v_pk_add_f32 v[146:147], v[144:145], 2.0 op_sel_hi:[1,0]
    v_pk_fma_f32 v[144:145], v[144:145], v[146:147], 2.0 op_sel_hi:[1,1,0]
    v_rcp_f32 v144, v144
    v_rcp_f32 v145, v145
    v_pk_mul_f32 v[140:141], v[140:141], v[62:63]
    v_pk_fma_f32 v[140:141], v[140:141], -2.0, v[62:63] op_sel_hi:[1,0,1]
    v_cvt_pk_bf16_f32 v125, v140, v141
    v_exp_f32 v140, v40
    v_exp_f32 v141, v41
    v_pk_add_f32 v[150:151], v[148:149], 2.0 op_sel_hi:[1,0]
    v_pk_fma_f32 v[148:149], v[148:149], v[150:151], 2.0 op_sel_hi:[1,1,0]
    v_rcp_f32 v148, v148
    v_rcp_f32 v149, v149
    v_pk_mul_f32 v[144:145], v[144:145], v[64:65]
    v_pk_fma_f32 v[144:145], v[144:145], -2.0, v[64:65] op_sel_hi:[1,0,1]
    v_cvt_pk_bf16_f32 v126, v144, v145
    v_exp_f32 v144, v42
    v_exp_f32 v145, v43
    v_pk_add_f32 v[142:143], v[140:141], 2.0 op_sel_hi:[1,0]
    v_pk_fma_f32 v[140:141], v[140:141], v[142:143], 2.0 op_sel_hi:[1,1,0]
    v_rcp_f32 v140, v140
    v_rcp_f32 v141, v141
    v_pk_mul_f32 v[148:149], v[148:149], v[66:67]
    v_pk_fma_f32 v[148:149], v[148:149], -2.0, v[66:67] op_sel_hi:[1,0,1]
    v_cvt_pk_bf16_f32 v127, v148, v149
    buffer_store_dwordx4 v[124:127], v2, s[32:35], s89 offen offset:2048 sc1
    v_exp_f32 v148, v68
    v_exp_f32 v149, v69
    v_pk_add_f32 v[146:147], v[144:145], 2.0 op_sel_hi:[1,0]
    v_pk_fma_f32 v[144:145], v[144:145], v[146:147], 2.0 op_sel_hi:[1,1,0]
    v_rcp_f32 v144, v144
    v_rcp_f32 v145, v145
    v_pk_mul_f32 v[140:141], v[140:141], v[40:41]
    v_pk_fma_f32 v[140:141], v[140:141], -2.0, v[40:41] op_sel_hi:[1,0,1]
    v_cvt_pk_bf16_f32 v112, v140, v141
    v_exp_f32 v140, v70
    v_exp_f32 v141, v71
    v_pk_add_f32 v[150:151], v[148:149], 2.0 op_sel_hi:[1,0]
    v_pk_fma_f32 v[148:149], v[148:149], v[150:151], 2.0 op_sel_hi:[1,1,0]
    v_rcp_f32 v148, v148
    v_rcp_f32 v149, v149
    v_pk_mul_f32 v[144:145], v[144:145], v[42:43]
    v_pk_fma_f32 v[144:145], v[144:145], -2.0, v[42:43] op_sel_hi:[1,0,1]
    v_cvt_pk_bf16_f32 v113, v144, v145
    s_mov_b64 exec, s[76:77]
    v_mov_b32 v112, 0
    v_mov_b32 v113, 0
    s_mov_b64 exec, -1
    buffer_store_dwordx2 v[112:113], v0, s[32:35], s90 offen sc1
    v_pk_add_f32 v[142:143], v[140:141], 2.0 op_sel_hi:[1,0]
    v_pk_fma_f32 v[140:141], v[140:141], v[142:143], 2.0 op_sel_hi:[1,1,0]
    v_rcp_f32 v140, v140
    v_rcp_f32 v141, v141
    v_pk_mul_f32 v[148:149], v[148:149], v[68:69]
    v_pk_fma_f32 v[148:149], v[148:149], -2.0, v[68:69] op_sel_hi:[1,0,1]
    v_cvt_pk_bf16_f32 v128, v148, v149
    v_pk_mul_f32 v[140:141], v[140:141], v[70:71]
    v_pk_fma_f32 v[140:141], v[140:141], -2.0, v[70:71] op_sel_hi:[1,0,1]
    v_cvt_pk_bf16_f32 v129, v140, v141
    s_mov_b64 exec, s[76:77]
    v_mov_b32 v128, 0
    v_mov_b32 v129, 0
    s_mov_b64 exec, -1
    buffer_store_dwordx2 v[128:129], v0, s[32:35], s91 offen sc1
    s_cmp_lg_u32 s11, 0
    s_waitcnt vmcnt(0)
    s_mov_b64 exec, 1
    s_cbranch_scc1 pubs_42
    buffer_store_dword v190, v191, s[32:35], s86 offen
pubb_43:
    s_mov_b64 exec, -1
    buffer_load_dword v16, v7, s[32:35], s87 offen offset:2048 sc1
    s_add_u32 s86, s86, 512
    s_mov_b32 s97, 0
poll_44:
    s_waitcnt vmcnt(0)
    v_cmp_ne_u32 vcc, s13, v16
    s_cbranch_vccnz pretry_46
pdone_45:
    s_cmp_lg_u32 s11, 0
    s_cbranch_scc1 ool_48
back_49:
    buffer_load_dwordx4 v[76:79], v2, s[32:35], s48 offen offset:0 sc1
    buffer_load_dwordx4 v[80:83], v2, s[32:35], s48 offen offset:1024 sc1
    buffer_load_dwordx4 v[84:87], v2, s[32:35], s48 offen offset:2048 sc1
    buffer_load_dwordx2 v[88:89], v0, s[32:35], s48 offen offset:3072 sc1
    buffer_load_dwordx2 v[90:91], v0, s[32:35], s48 offen offset:3584 sc1
    buffer_load_dwordx4 v[92:95], v2, s[32:35], s49 offen offset:0 sc1
    buffer_load_dwordx4 v[96:99], v2, s[32:35], s49 offen offset:1024 sc1
    buffer_load_dwordx4 v[100:103], v2, s[32:35], s49 offen offset:2048 sc1
    buffer_load_dwordx4 v[104:107], v2, s[32:35], s49 offen offset:3072 sc1
    s_add_u32 s87, s87, 512
    s_waitcnt vmcnt(8)
    v_mfma_f32_16x16x32_bf16 v[16:19], a[0:3], v[76:79], 0
    buffer_load_dwordx4 v[108:111], v2, s[32:35], s50 offen offset:0 sc1
    buffer_load_dwordx4 v[112:115], v2, s[32:35], s50 offen offset:1024 sc1
    v_mfma_f32_16x16x32_bf16 v[20:23], a[4:7], v[76:79], 0
    v_mfma_f32_16x16x32_bf16 v[24:27], a[8:11], v[76:79], 0
    v_mfma_f32_16x16x32_bf16 v[28:31], a[12:15], v[76:79], 0
    v_mfma_f32_16x16x32_bf16 v[32:35], a[16:19], v[76:79], 0
    s_waitcnt vmcnt(9)
    v_mfma_f32_16x16x32_bf16 v[16:19], a[20:23], v[80:83], v[16:19]
    buffer_load_dwordx2 v[116:117], v0, s[32:35], s50 offen offset:2048 sc1
    buffer_load_dwordx2 v[118:119], v0, s[32:35], s50 offen offset:2560 sc1
    buffer_load_dwordx4 v[120:123], v2, s[32:35], s50 offen offset:3072 sc1
    v_mfma_f32_16x16x32_bf16 v[20:23], a[24:27], v[80:83], v[20:23]
    v_mfma_f32_16x16x32_bf16 v[24:27], a[28:31], v[80:83], v[24:27]
    v_mfma_f32_16x16x32_bf16 v[28:31], a[32:35], v[80:83], v[28:31]
    v_mfma_f32_16x16x32_bf16 v[32:35], a[36:39], v[80:83], v[32:35]
    s_waitcnt vmcnt(11)
    v_mfma_f32_16x16x32_bf16 v[16:19], a[40:43], v[84:87], v[16:19]
    buffer_load_dwordx4 v[124:127], v2, s[32:35], s51 offen offset:0 sc1
    buffer_load_dwordx4 v[128:131], v2, s[32:35], s51 offen offset:1024 sc1
    v_mfma_f32_16x16x32_bf16 v[20:23], a[44:47], v[84:87], v[20:23]
    v_mfma_f32_16x16x32_bf16 v[24:27], a[48:51], v[84:87], v[24:27]
    v_mfma_f32_16x16x32_bf16 v[28:31], a[52:55], v[84:87], v[28:31]
    v_mfma_f32_16x16x32_bf16 v[32:35], a[56:59], v[84:87], v[32:35]
    s_waitcnt vmcnt(11)
    v_mfma_f32_16x16x32_bf16 v[16:19], a[60:63], v[88:91], v[16:19]
    buffer_load_dwordx4 v[132:135], v2, s[32:35], s52 offen offset:0 sc1
    buffer_load_dwordx4 v[136:139], v2, s[32:35], s52 offen offset:1024 sc1
    v_mfma_f32_16x16x32_bf16 v[20:23], a[64:67], v[88:91], v[20:23]
    v_mfma_f32_16x16x32_bf16 v[24:27], a[68:71], v[88:91], v[24:27]
    v_mfma_f32_16x16x32_bf16 v[28:31], a[72:75], v[88:91], v[28:31]
    v_mfma_f32_16x16x32_bf16 v[32:35], a[76:79], v[88:91], v[32:35]
    s_waitcnt vmcnt(12)
    v_mfma_f32_16x16x32_bf16 v[16:19], a[80:83], v[92:95], v[16:19]
    buffer_load_dwordx4 v[140:143], v2, s[32:35], s52 offen offset:2048 sc1
    v_mfma_f32_16x16x32_bf16 v[20:23], a[84:87], v[92:95], v[20:23]
    v_mfma_f32_16x16x32_bf16 v[24:27], a[88:91], v[92:95], v[24:27]
    v_mfma_f32_16x16x32_bf16 v[28:31], a[92:95], v[92:95], v[28:31]
    v_mfma_f32_16x16x32_bf16 v[32:35], a[96:99], v[92:95], v[32:35]
    s_waitcnt vmcnt(12)
    v_mfma_f32_16x16x32_bf16 v[16:19], a[100:103], v[96:99], v[16:19]
    buffer_load_dwordx2 v[144:145], v0, s[32:35], s52 offen offset:3072 sc1
    buffer_load_dwordx2 v[146:147], v0, s[32:35], s52 offen offset:3584 sc1
    v_mfma_f32_16x16x32_bf16 v[20:23], a[104:107], v[96:99], v[20:23]
    v_mfma_f32_16x16x32_bf16 v[24:27], a[108:111], v[96:99], v[24:27]
    v_mfma_f32_16x16x32_bf16 v[28:31], a[112:115], v[96:99], v[28:31]
    v_mfma_f32_16x16x32_bf16 v[32:35], a[116:119], v[96:99], v[32:35]
    s_waitcnt vmcnt(13)
    v_mfma_f32_16x16x32_bf16 v[16:19], a[120:123], v[100:103], v[16:19]
    buffer_load_dwordx4 v[148:151], v2, s[32:35], s53 offen offset:0 sc1
    v_mfma_f32_16x16x32_bf16 v[20:23], a[124:127], v[100:103], v[20:23]
    v_mfma_f32_16x16x32_bf16 v[24:27], a[128:131], v[100:103], v[24:27]
    v_mfma_f32_16x16x32_bf16 v[28:31], a[132:135], v[100:103], v[28:31]
    v_mfma_f32_16x16x32_bf16 v[32:35], a[136:139], v[100:103], v[32:35]
    s_waitcnt vmcnt(13)
    v_mfma_f32_16x16x32_bf16 v[16:19], a[140:143], v[104:107], v[16:19]
    buffer_load_dwordx4 v[152:155], v2, s[32:35], s53 offen offset:1024 sc1
    v_mfma_f32_16x16x32_bf16 v[20:23], a[144:147], v[104:107], v[20:23]
    v_mfma_f32_16x16x32_bf16 v[24:27], a[148:151], v[104:107], v[24:27]
    v_mfma_f32_16x16x32_bf16 v[28:31], a[152:155], v[104:107], v[28:31]
    v_mfma_f32_16x16x32_bf16 v[32:35], a[156:159], v[104:107], v[32:35]
    s_waitcnt vmcnt(13)
    v_mfma_f32_16x16x32_bf16 v[16:19], a[160:163], v[108:111], v[16:19]
    buffer_load_dwordx4 v[156:159], v2, s[32:35], s53 offen offset:2048 sc1
    v_mfma_f32_16x16x32_bf16 v[20:23], a[164:167], v[108:111], v[20:23]
    v_mfma_f32_16x16x32_bf16 v[24:27], a[168:171], v[108:111], v[24:27]
    v_mfma_f32_16x16x32_bf16 v[28:31], a[172:175], v[108:111], v[28:31]
    v_mfma_f32_16x16x32_bf16 v[32:35], a[176:179], v[108:111], v[32:35]
    s_waitcnt vmcnt(13)
    v_mfma_f32_16x16x32_bf16 v[16:19], a[180:183], v[112:115], v[16:19]
    buffer_load_dwordx4 v[160:163], v2, s[32:35], s53 offen offset:3072 sc1
    v_mfma_f32_16x16x32_bf16 v[20:23], a[184:187], v[112:115], v[20:23]
    v_mfma_f32_16x16x32_bf16 v[24:27], a[188:191], v[112:115], v[24:27]
    v_mfma_f32_16x16x32_bf16 v[28:31], a[192:195], v[112:115], v[28:31]
    v_mfma_f32_16x16x32_bf16 v[32:35], a[196:199], v[112:115], v[32:35]
    s_waitcnt vmcnt(12)
    v_mfma_f32_16x16x32_bf16 v[16:19], a[200:203], v[116:119], v[16:19]
    buffer_load_dwordx4 v[164:167], v2, s[32:35], s54 offen offset:0 sc1
    v_mfma_f32_16x16x32_bf16 v[20:23], a[204:207], v[116:119], v[20:23]
    v_mfma_f32_16x16x32_bf16 v[24:27], a[208:211], v[116:119], v[24:27]
    v_mfma_f32_16x16x32_bf16 v[28:31], a[212:215], v[116:119], v[28:31]
    v_mfma_f32_16x16x32_bf16 v[32:35], a[216:219], v[116:119], v[32:35]
    s_waitcnt vmcnt(12)
    v_mfma_f32_16x16x32_bf16 v[16:19], a[220:223], v[120:123], v[16:19]
    buffer_load_dwordx4 v[168:171], v2, s[32:35], s54 offen offset:1024 sc1
    v_mfma_f32_16x16x32_bf16 v[20:23], a[224:227], v[120:123], v[20:23]
    v_mfma_f32_16x16x32_bf16 v[24:27], a[228:231], v[120:123], v[24:27]
    v_mfma_f32_16x16x32_bf16 v[28:31], a[232:235], v[120:123], v[28:31]
    v_mfma_f32_16x16x32_bf16 v[32:35], a[236:239], v[120:123], v[32:35]
    s_waitcnt vmcnt(12)
    v_mfma_f32_16x16x32_bf16 v[16:19], a[240:243], v[124:127], v[16:19]
    buffer_load_dwordx2 v[172:173], v0, s[32:35], s54 offen offset:2048 sc1
    buffer_load_dwordx2 v[174:175], v0, s[32:35], s54 offen offset:2560 sc1
    v_mfma_f32_16x16x32_bf16 v[20:23], a[244:247], v[124:127], v[20:23]
    v_mfma_f32_16x16x32_bf16 v[24:27], a[248:251], v[124:127], v[24:27]
    v_mfma_f32_16x16x32_bf16 v[28:31], a[252:255], v[124:127], v[28:31]
    v_mfma_f32_16x16x32_bf16 v[32:35], v[232:235], v[124:127], v[32:35]
    s_waitcnt vmcnt(13)
    v_mfma_f32_16x16x32_bf16 v[16:19], v[236:239], v[128:131], v[16:19]
    buffer_load_dwordx4 v[176:179], v2, s[32:35], s54 offen offset:3072 sc1
    v_mfma_f32_16x16x32_bf16 v[20:23], v[240:243], v[128:131], v[20:23]
    v_mfma_f32_16x16x32_bf16 v[24:27], v[244:247], v[128:131], v[24:27]
    v_mfma_f32_16x16x32_bf16 v[28:31], v[248:251], v[128:131], v[28:31]
    v_mfma_f32_16x16x32_bf16 v[32:35], v[252:255], v[128:131], v[32:35]
    s_waitcnt vmcnt(13)
    v_mfma_f32_16x16x32_bf16 v[36:39], a[0:3], v[132:135], 0
    buffer_load_dwordx4 v[180:183], v2, s[32:35], s55 offen offset:0 sc1
    v_mfma_f32_16x16x32_bf16 v[40:43], a[4:7], v[132:135], 0
    v_mfma_f32_16x16x32_bf16 v[44:47], a[8:11], v[132:135], 0
    v_mfma_f32_16x16x32_bf16 v[48:51], a[12:15], v[132:135], 0
    v_mfma_f32_16x16x32_bf16 v[52:55], a[16:19], v[132:135], 0
    s_waitcnt vmcnt(13)
    v_mfma_f32_16x16x32_bf16 v[36:39], a[20:23], v[136:139], v[36:39]
    buffer_load_dwordx4 v[184:187], v2, s[32:35], s55 offen offset:1024 sc1
    v_mfma_f32_16x16x32_bf16 v[40:43], a[24:27], v[136:139], v[40:43]
    ds_write_b128 v8, v[16:19] offset:0
    v_mfma_f32_16x16x32_bf16 v[44:47], a[28:31], v[136:139], v[44:47]
    v_mfma_f32_16x16x32_bf16 v[48:51], a[32:35], v[136:139], v[48:51]
    v_mfma_f32_16x16x32_bf16 v[52:55], a[36:39], v[136:139], v[52:55]
    s_waitcnt vmcnt(13)
    v_mfma_f32_16x16x32_bf16 v[36:39], a[40:43], v[140:143], v[36:39]
    buffer_load_dwordx4 v[76:79], v2, s[32:35], s56 offen offset:0 sc1
    v_mfma_f32_16x16x32_bf16 v[40:43], a[44:47], v[140:143], v[40:43]
    v_mfma_f32_16x16x32_bf16 v[44:47], a[48:51], v[140:143], v[44:47]
    v_mfma_f32_16x16x32_bf16 v[48:51], a[52:55], v[140:143], v[48:51]
    v_mfma_f32_16x16x32_bf16 v[52:55], a[56:59], v[140:143], v[52:55]
    s_waitcnt vmcnt(12)
    v_mfma_f32_16x16x32_bf16 v[36:39], a[60:63], v[144:147], v[36:39]
    buffer_load_dwordx4 v[80:83], v2, s[32:35], s56 offen offset:1024 sc1
    v_mfma_f32_16x16x32_bf16 v[40:43], a[64:67], v[144:147], v[40:43]
    ds_write_b128 v8, v[20:23] offset:1024
    v_mfma_f32_16x16x32_bf16 v[44:47], a[68:71], v[144:147], v[44:47]
    v_mfma_f32_16x16x32_bf16 v[48:51], a[72:75], v[144:147], v[48:51]
    v_mfma_f32_16x16x32_bf16 v[52:55], a[76:79], v[144:147], v[52:55]
    s_waitcnt vmcnt(12)
    v_mfma_f32_16x16x32_bf16 v[36:39], a[80:83], v[148:151], v[36:39]
    buffer_load_dwordx4 v[84:87], v2, s[32:35], s56 offen offset:2048 sc1
    v_mfma_f32_16x16x32_bf16 v[40:43], a[84:87], v[148:151], v[40:43]
    v_mfma_f32_16x16x32_bf16 v[44:47], a[88:91], v[148:151], v[44:47]
    v_mfma_f32_16x16x32_bf16 v[48:51], a[92:95], v[148:151], v[48:51]
    v_mfma_f32_16x16x32_bf16 v[52:55], a[96:99], v[148:151], v[52:55]
    s_waitcnt vmcnt(12)
    v_mfma_f32_16x16x32_bf16 v[36:39], a[100:103], v[152:155], v[36:39]
    buffer_load_dwordx2 v[88:89], v0, s[32:35], s56 offen offset:3072 sc1
    buffer_load_dwordx2 v[90:91], v0, s[32:35], s56 offen offset:3584 sc1
    v_mfma_f32_16x16x32_bf16 v[40:43], a[104:107], v[152:155], v[40:43]
    ds_write_b128 v8, v[24:27] offset:2048
    v_mfma_f32_16x16x32_bf16 v[44:47], a[108:111], v[152:155], v[44:47]
    v_mfma_f32_16x16x32_bf16 v[48:51], a[112:115], v[152:155], v[48:51]
    v_mfma_f32_16x16x32_bf16 v[52:55], a[116:119], v[152:155], v[52:55]
    s_waitcnt vmcnt(13)
    v_mfma_f32_16x16x32_bf16 v[36:39], a[120:123], v[156:159], v[36:39]
    buffer_load_dwordx4 v[92:95], v2, s[32:35], s57 offen offset:0 sc1
    v_mfma_f32_16x16x32_bf16 v[40:43], a[124:127], v[156:159], v[40:43]
    v_mfma_f32_16x16x32_bf16 v[44:47], a[128:131], v[156:159], v[44:47]
    v_mfma_f32_16x16x32_bf16 v[48:51], a[132:135], v[156:159], v[48:51]
    v_mfma_f32_16x16x32_bf16 v[52:55], a[136:139], v[156:159], v[52:55]
    s_waitcnt vmcnt(13)
    v_mfma_f32_16x16x32_bf16 v[36:39], a[140:143], v[160:163], v[36:39]
    buffer_load_dwordx4 v[96:99], v2, s[32:35], s57 offen offset:1024 sc1
    v_mfma_f32_16x16x32_bf16 v[40:43], a[144:147], v[160:163], v[40:43]
    ds_write_b128 v8, v[28:31] offset:3072
    v_mfma_f32_16x16x32_bf16 v[44:47], a[148:151], v[160:163], v[44:47]
    v_mfma_f32_16x16x32_bf16 v[48:51], a[152:155], v[160:163], v[48:51]
    v_mfma_f32_16x16x32_bf16 v[52:55], a[156:159], v[160:163], v[52:55]
    s_waitcnt vmcnt(13)
    v_mfma_f32_16x16x32_bf16 v[36:39], a[160:163], v[164:167], v[36:39]
    buffer_load_dwordx4 v[100:103], v2, s[32:35], s57 offen offset:2048 sc1
    v_mfma_f32_16x16x32_bf16 v[40:43], a[164:167], v[164:167], v[40:43]
    v_mfma_f32_16x16x32_bf16 v[44:47], a[168:171], v[164:167], v[44:47]
    v_mfma_f32_16x16x32_bf16 v[48:51], a[172:175], v[164:167], v[48:51]
    v_mfma_f32_16x16x32_bf16 v[52:55], a[176:179], v[164:167], v[52:55]
    s_waitcnt vmcnt(13)
    v_mfma_f32_16x16x32_bf16 v[36:39], a[180:183], v[168:171], v[36:39]
    buffer_load_dwordx4 v[104:107], v2, s[32:35], s57 offen offset:3072 sc1
    v_mfma_f32_16x16x32_bf16 v[40:43], a[184:187], v[168:171], v[40:43]
    ds_write_b128 v8, v[32:35] offset:4096
    v_mfma_f32_16x16x32_bf16 v[44:47], a[188:191], v[168:171], v[44:47]
    v_mfma_f32_16x16x32_bf16 v[48:51], a[192:195], v[168:171], v[48:51]
    v_mfma_f32_16x16x32_bf16 v[52:55], a[196:199], v[168:171], v[52:55]
    s_waitcnt vmcnt(12)
    v_mfma_f32_16x16x32_bf16 v[36:39], a[200:203], v[172:175], v[36:39]
    buffer_load_dwordx4 v[108:111], v2, s[32:35], s58 offen offset:0 sc1
    v_mfma_f32_16x16x32_bf16 v[40:43], a[204:207], v[172:175], v[40:43]
    v_mfma_f32_16x16x32_bf16 v[44:47], a[208:211], v[172:175], v[44:47]
    v_mfma_f32_16x16x32_bf16 v[48:51], a[212:215], v[172:175], v[48:51]
    v_mfma_f32_16x16x32_bf16 v[52:55], a[216:219], v[172:175], v[52:55]
    s_waitcnt vmcnt(12)
    v_mfma_f32_16x16x32_bf16 v[36:39], a[220:223], v[176:179], v[36:39]
    buffer_load_dwordx4 v[112:115], v2, s[32:35], s58 offen offset:1024 sc1
    v_mfma_f32_16x16x32_bf16 v[40:43], a[224:227], v[176:179], v[40:43]
    v_mfma_f32_16x16x32_bf16 v[44:47], a[228:231], v[176:179], v[44:47]
    v_mfma_f32_16x16x32_bf16 v[48:51], a[232:235], v[176:179], v[48:51]
    v_mfma_f32_16x16x32_bf16 v[52:55], a[236:239], v[176:179], v[52:55]
    s_waitcnt vmcnt(12)
    v_mfma_f32_16x16x32_bf16 v[36:39], a[240:243], v[180:183], v[36:39]
    buffer_load_dwordx2 v[116:117], v0, s[32:35], s58 offen offset:2048 sc1
    buffer_load_dwordx2 v[118:119], v0, s[32:35], s58 offen offset:2560 sc1
    v_mfma_f32_16x16x32_bf16 v[40:43], a[244:247], v[180:183], v[40:43]
    s_waitcnt lgkmcnt(0)
    s_barrier
    v_mfma_f32_16x16x32_bf16 v[44:47], a[248:251], v[180:183], v[44:47]
    ds_read_b128 v[56:59], v9 offset:0
    v_mfma_f32_16x16x32_bf16 v[48:51], a[252:255], v[180:183], v[48:51]
    ds_read_b128 v[60:63], v9 offset:1024
    v_mfma_f32_16x16x32_bf16 v[52:55], v[232:235], v[180:183], v[52:55]
    s_waitcnt vmcnt(13)
    v_mfma_f32_16x16x32_bf16 v[36:39], v[236:239], v[184:187], v[36:39]
    buffer_load_dwordx4 v[120:123], v2, s[32:35], s58 offen offset:3072 sc1
    v_mfma_f32_16x16x32_bf16 v[40:43], v[240:243], v[184:187], v[40:43]
    ds_read_b128 v[64:67], v9 offset:2048
    v_mfma_f32_16x16x32_bf16 v[44:47], v[244:247], v[184:187], v[44:47]
    ds_read_b128 v[68:71], v9 offset:3072
    v_mfma_f32_16x16x32_bf16 v[48:51], v[248:251], v[184:187], v[48:51]
    ds_read_b128 v[72:75], v9 offset:4096
    v_mfma_f32_16x16x32_bf16 v[52:55], v[252:255], v[184:187], v[52:55]
    s_waitcnt vmcnt(13)
    v_mfma_f32_16x16x32_bf16 v[16:19], a[0:3], v[76:79], 0
    buffer_load_dwordx4 v[124:127], v2, s[32:35], s59 offen offset:0 sc1
    v_mfma_f32_16x16x32_bf16 v[20:23], a[4:7], v[76:79], 0
    v_mfma_f32_16x16x32_bf16 v[24:27], a[8:11], v[76:79], 0
    v_mfma_f32_16x16x32_bf16 v[28:31], a[12:15], v[76:79], 0
    v_mfma_f32_16x16x32_bf16 v[32:35], a[16:19], v[76:79], 0
    s_waitcnt vmcnt(13)
    v_mfma_f32_16x16x32_bf16 v[16:19], a[20:23], v[80:83], v[16:19]
    buffer_load_dwordx4 v[128:131], v2, s[32:35], s59 offen offset:1024 sc1
    v_mfma_f32_16x16x32_bf16 v[20:23], a[24:27], v[80:83], v[20:23]
    s_waitcnt lgkmcnt(0)
    v_mfma_f32_16x16x32_bf16 v[24:27], a[28:31], v[80:83], v[24:27]
    ds_write_b128 v9, v[36:39] offset:0
    v_mfma_f32_16x16x32_bf16 v[28:31], a[32:35], v[80:83], v[28:31]
    v_mfma_f32_16x16x32_bf16 v[32:35], a[36:39], v[80:83], v[32:35]
    s_waitcnt vmcnt(13)
    v_mfma_f32_16x16x32_bf16 v[16:19], a[40:43], v[84:87], v[16:19]
    buffer_load_dwordx4 v[132:135], v2, s[32:35], s60 offen offset:0 sc1
    v_mfma_f32_16x16x32_bf16 v[20:23], a[44:47], v[84:87], v[20:23]
    v_fmac_f32 v212, s72, v56
    v_fmac_f32 v213, s72, v57
    v_mfma_f32_16x16x32_bf16 v[24:27], a[48:51], v[84:87], v[24:27]
    v_fmac_f32 v214, s72, v58
    v_fmac_f32 v215, s72, v59
    v_mfma_f32_16x16x32_bf16 v[28:31], a[52:55], v[84:87], v[28:31]
    v_mfma_f32_16x16x32_bf16 v[32:35], a[56:59], v[84:87], v[32:35]
    s_waitcnt vmcnt(12)
    v_mfma_f32_16x16x32_bf16 v[16:19], a[60:63], v[88:91], v[16:19]
    buffer_load_dwordx4 v[136:139], v2, s[32:35], s60 offen offset:1024 sc1
    v_mfma_f32_16x16x32_bf16 v[20:23], a[64:67], v[88:91], v[20:23]
    ds_write_b128 v9, v[40:43] offset:1024
    v_mfma_f32_16x16x32_bf16 v[24:27], a[68:71], v[88:91], v[24:27]
    v_mfma_f32_16x16x32_bf16 v[28:31], a[72:75], v[88:91], v[28:31]
    v_mfma_f32_16x16x32_bf16 v[32:35], a[76:79], v[88:91], v[32:35]
    s_waitcnt vmcnt(12)
    v_mfma_f32_16x16x32_bf16 v[16:19], a[80:83], v[92:95], v[16:19]
    buffer_load_dwordx4 v[140:143], v2, s[32:35], s60 offen offset:2048 sc1
    v_mfma_f32_16x16x32_bf16 v[20:23], a[84:87], v[92:95], v[20:23]
    v_fmac_f32 v216, s72, v60
    v_fmac_f32 v217, s72, v61
    v_mfma_f32_16x16x32_bf16 v[24:27], a[88:91], v[92:95], v[24:27]
    v_fmac_f32 v218, s72, v62
    v_fmac_f32 v219, s72, v63
    v_mfma_f32_16x16x32_bf16 v[28:31], a[92:95], v[92:95], v[28:31]
    v_mfma_f32_16x16x32_bf16 v[32:35], a[96:99], v[92:95], v[32:35]
    s_waitcnt vmcnt(12)
    v_mfma_f32_16x16x32_bf16 v[16:19], a[100:103], v[96:99], v[16:19]
    buffer_load_dwordx2 v[144:145], v0, s[32:35], s60 offen offset:3072 sc1
    buffer_load_dwordx2 v[146:147], v0, s[32:35], s60 offen offset:3584 sc1
    v_mfma_f32_16x16x32_bf16 v[20:23], a[104:107], v[96:99], v[20:23]
    ds_write_b128 v9, v[44:47] offset:2048
    v_mfma_f32_16x16x32_bf16 v[24:27], a[108:111], v[96:99], v[24:27]
    v_mfma_f32_16x16x32_bf16 v[28:31], a[112:115], v[96:99], v[28:31]
    v_mfma_f32_16x16x32_bf16 v[32:35], a[116:119], v[96:99], v[32:35]
    s_waitcnt vmcnt(13)
    v_mfma_f32_16x16x32_bf16 v[16:19], a[120:123], v[100:103], v[16:19]
    buffer_load_dwordx4 v[148:151], v2, s[32:35], s61 offen offset:0 sc1
    v_mfma_f32_16x16x32_bf16 v[20:23], a[124:127], v[100:103], v[20:23]
    v_fmac_f32 v220, s72, v64
    v_fmac_f32 v221, s72, v65
    v_mfma_f32_16x16x32_bf16 v[24:27], a[128:131], v[100:103], v[24:27]
    v_fmac_f32 v222, s72, v66
    v_fmac_f32 v223, s72, v67
    v_mfma_f32_16x16x32_bf16 v[28:31], a[132:135], v[100:103], v[28:31]
    v_mfma_f32_16x16x32_bf16 v[32:35], a[136:139], v[100:103], v[32:35]
    s_waitcnt vmcnt(13)
    v_mfma_f32_16x16x32_bf16 v[16:19], a[140:143], v[104:107], v[16:19]
    buffer_load_dwordx4 v[152:155], v2, s[32:35], s61 offen offset:1024 sc1
    v_mfma_f32_16x16x32_bf16 v[20:23], a[144:147], v[104:107], v[20:23]
    ds_write_b128 v9, v[48:51] offset:3072
    v_mfma_f32_16x16x32_bf16 v[24:27], a[148:151], v[104:107], v[24:27]
    v_mfma_f32_16x16x32_bf16 v[28:31], a[152:155], v[104:107], v[28:31]
    v_mfma_f32_16x16x32_bf16 v[32:35], a[156:159], v[104:107], v[32:35]
    s_waitcnt vmcnt(13)
    v_mfma_f32_16x16x32_bf16 v[16:19], a[160:163], v[108:111], v[16:19]
    buffer_load_dwordx4 v[156:159], v2, s[32:35], s61 offen offset:2048 sc1
    v_mfma_f32_16x16x32_bf16 v[20:23], a[164:167], v[108:111], v[20:23]
    v_fmac_f32 v224, s72, v68
    v_fmac_f32 v225, s72, v69
    v_mfma_f32_16x16x32_bf16 v[24:27], a[168:171], v[108:111], v[24:27]
    v_fmac_f32 v226, s72, v70
    v_fmac_f32 v227, s72, v71
    v_mfma_f32_16x16x32_bf16 v[28:31], a[172:175], v[108:111], v[28:31]
    v_mfma_f32_16x16x32_bf16 v[32:35], a[176:179], v[108:111], v[32:35]
    s_waitcnt vmcnt(13)
    v_mfma_f32_16x16x32_bf16 v[16:19], a[180:183], v[112:115], v[16:19]
    buffer_load_dwordx4 v[160:163], v2, s[32:35], s61 offen offset:3072 sc1
    v_mfma_f32_16x16x32_bf16 v[20:23], a[184:187], v[112:115], v[20:23]
    ds_write_b128 v9, v[52:55] offset:4096
    v_mfma_f32_16x16x32_bf16 v[24:27], a[188:191], v[112:115], v[24:27]
    v_mfma_f32_16x16x32_bf16 v[28:31], a[192:195], v[112:115], v[28:31]
    v_mfma_f32_16x16x32_bf16 v[32:35], a[196:199], v[112:115], v[32:35]
    s_waitcnt vmcnt(12)
    v_mfma_f32_16x16x32_bf16 v[16:19], a[200:203], v[116:119], v[16:19]
    buffer_load_dwordx4 v[164:167], v2, s[32:35], s62 offen offset:0 sc1
    v_mfma_f32_16x16x32_bf16 v[20:23], a[204:207], v[116:119], v[20:23]
    v_fmac_f32 v228, s72, v72
    v_fmac_f32 v229, s72, v73
    v_mfma_f32_16x16x32_bf16 v[24:27], a[208:211], v[116:119], v[24:27]
    v_fmac_f32 v230, s72, v74
    v_fmac_f32 v231, s72, v75
    v_mfma_f32_16x16x32_bf16 v[28:31], a[212:215], v[116:119], v[28:31]
    v_mfma_f32_16x16x32_bf16 v[32:35], a[216:219], v[116:119], v[32:35]
    s_waitcnt vmcnt(12)
    v_mfma_f32_16x16x32_bf16 v[16:19], a[220:223], v[120:123], v[16:19]
    buffer_load_dwordx4 v[168:171], v2, s[32:35], s62 offen offset:1024 sc1
    v_mfma_f32_16x16x32_bf16 v[20:23], a[224:227], v[120:123], v[20:23]
    v_mfma_f32_16x16x32_bf16 v[24:27], a[228:231], v[120:123], v[24:27]
    v_mfma_f32_16x16x32_bf16 v[28:31], a[232:235], v[120:123], v[28:31]
    v_mfma_f32_16x16x32_bf16 v[32:35], a[236:239], v[120:123], v[32:35]
    s_waitcnt vmcnt(12)
    v_mfma_f32_16x16x32_bf16 v[16:19], a[240:243], v[124:127], v[16:19]
    buffer_load_dwordx2 v[172:173], v0, s[32:35], s62 offen offset:2048 sc1
    buffer_load_dwordx2 v[174:175], v0, s[32:35], s62 offen offset:2560 sc1
    v_mfma_f32_16x16x32_bf16 v[20:23], a[244:247], v[124:127], v[20:23]
    s_waitcnt lgkmcnt(0)
    s_barrier
    v_mfma_f32_16x16x32_bf16 v[24:27], a[248:251], v[124:127], v[24:27]
    ds_read_b128 v[56:59], v10 offset:0
    v_mfma_f32_16x16x32_bf16 v[28:31], a[252:255], v[124:127], v[28:31]
    ds_read_b128 v[60:63], v10 offset:1024
    v_mfma_f32_16x16x32_bf16 v[32:35], v[232:235], v[124:127], v[32:35]
    s_waitcnt vmcnt(13)
    v_mfma_f32_16x16x32_bf16 v[16:19], v[236:239], v[128:131], v[16:19]
    buffer_load_dwordx4 v[176:179], v2, s[32:35], s62 offen offset:3072 sc1
    v_mfma_f32_16x16x32_bf16 v[20:23], v[240:243], v[128:131], v[20:23]
    ds_read_b128 v[64:67], v10 offset:2048
    v_mfma_f32_16x16x32_bf16 v[24:27], v[244:247], v[128:131], v[24:27]
    ds_read_b128 v[68:71], v10 offset:3072
    v_mfma_f32_16x16x32_bf16 v[28:31], v[248:251], v[128:131], v[28:31]
    ds_read_b128 v[72:75], v10 offset:4096
    v_mfma_f32_16x16x32_bf16 v[32:35], v[252:255], v[128:131], v[32:35]
    s_waitcnt vmcnt(13)
    v_mfma_f32_16x16x32_bf16 v[36:39], a[0:3], v[132:135], 0
    buffer_load_dwordx4 v[180:183], v2, s[32:35], s63 offen offset:0 sc1
    v_mfma_f32_16x16x32_bf16 v[40:43], a[4:7], v[132:135], 0
    v_mfma_f32_16x16x32_bf16 v[44:47], a[8:11], v[132:135], 0
    v_mfma_f32_16x16x32_bf16 v[48:51], a[12:15], v[132:135], 0
    v_mfma_f32_16x16x32_bf16 v[52:55], a[16:19], v[132:135], 0
    s_waitcnt vmcnt(13)
    v_mfma_f32_16x16x32_bf16 v[36:39], a[20:23], v[136:139], v[36:39]
    buffer_load_dwordx4 v[184:187], v2, s[32:35], s63 offen offset:1024 sc1
    v_mfma_f32_16x16x32_bf16 v[40:43], a[24:27], v[136:139], v[40:43]
    s_waitcnt lgkmcnt(0)
    v_mfma_f32_16x16x32_bf16 v[44:47], a[28:31], v[136:139], v[44:47]
    ds_write_b128 v10, v[16:19] offset:0
    v_mfma_f32_16x16x32_bf16 v[48:51], a[32:35], v[136:139], v[48:51]
    v_fmac_f32 v212, s72, v56
    v_fmac_f32 v213, s72, v57
    v_mfma_f32_16x16x32_bf16 v[52:55], a[36:39], v[136:139], v[52:55]
    s_waitcnt vmcnt(13)
    v_mfma_f32_16x16x32_bf16 v[36:39], a[40:43], v[140:143], v[36:39]
    v_mfma_f32_16x16x32_bf16 v[40:43], a[44:47], v[140:143], v[40:43]
    ds_write_b128 v10, v[20:23] offset:1024
    v_mfma_f32_16x16x32_bf16 v[44:47], a[48:51], v[140:143], v[44:47]
    v_fmac_f32 v214, s72, v58
    v_fmac_f32 v215, s72, v59
    v_mfma_f32_16x16x32_bf16 v[48:51], a[52:55], v[140:143], v[48:51]
    v_mfma_f32_16x16x32_bf16 v[52:55], a[56:59], v[140:143], v[52:55]
    s_waitcnt vmcnt(11)
    v_mfma_f32_16x16x32_bf16 v[36:39], a[60:63], v[144:147], v[36:39]
    v_mfma_f32_16x16x32_bf16 v[40:43], a[64:67], v[144:147], v[40:43]
    ds_write_b128 v10, v[24:27] offset:2048
    v_mfma_f32_16x16x32_bf16 v[44:47], a[68:71], v[144:147], v[44:47]
    v_fmac_f32 v216, s72, v60
    v_fmac_f32 v217, s72, v61
    v_mfma_f32_16x16x32_bf16 v[48:51], a[72:75], v[144:147], v[48:51]
    v_mfma_f32_16x16x32_bf16 v[52:55], a[76:79], v[144:147], v[52:55]
    s_waitcnt vmcnt(10)
    v_mfma_f32_16x16x32_bf16 v[36:39], a[80:83], v[148:151], v[36:39]
    v_mfma_f32_16x16x32_bf16 v[40:43], a[84:87], v[148:151], v[40:43]
    ds_write_b128 v10, v[28:31] offset:3072
    v_mfma_f32_16x16x32_bf16 v[44:47], a[88:91], v[148:151], v[44:47]
    v_fmac_f32 v218, s72, v62
    v_fmac_f32 v219, s72, v63
    v_mfma_f32_16x16x32_bf16 v[48:51], a[92:95], v[148:151], v[48:51]
    v_mfma_f32_16x16x32_bf16 v[52:55], a[96:99], v[148:151], v[52:55]
    s_waitcnt vmcnt(9)
    v_mfma_f32_16x16x32_bf16 v[36:39], a[100:103], v[152:155], v[36:39]
    v_mfma_f32_16x16x32_bf16 v[40:43], a[104:107], v[152:155], v[40:43]
    ds_write_b128 v10, v[32:35] offset:4096
    v_mfma_f32_16x16x32_bf16 v[44:47], a[108:111], v[152:155], v[44:47]
    v_fmac_f32 v220, s72, v64
    v_fmac_f32 v221, s72, v65
    v_mfma_f32_16x16x32_bf16 v[48:51], a[112:115], v[152:155], v[48:51]
    v_mfma_f32_16x16x32_bf16 v[52:55], a[116:119], v[152:155], v[52:55]
    s_waitcnt vmcnt(8)
    v_mfma_f32_16x16x32_bf16 v[36:39], a[120:123], v[156:159], v[36:39]
    v_mfma_f32_16x16x32_bf16 v[40:43], a[124:127], v[156:159], v[40:43]
    v_fmac_f32 v222, s72, v66
    v_fmac_f32 v223, s72, v67
    v_mfma_f32_16x16x32_bf16 v[44:47], a[128:131], v[156:159], v[44:47]
    v_fmac_f32 v224, s72, v68
    v_fmac_f32 v225, s72, v69
    v_mfma_f32_16x16x32_bf16 v[48:51], a[132:135], v[156:159], v[48:51]
    v_mfma_f32_16x16x32_bf16 v[52:55], a[136:139], v[156:159], v[52:55]
    s_waitcnt vmcnt(7)
    v_mfma_f32_16x16x32_bf16 v[36:39], a[140:143], v[160:163], v[36:39]
    v_mfma_f32_16x16x32_bf16 v[40:43], a[144:147], v[160:163], v[40:43]
    s_waitcnt lgkmcnt(0)
    s_barrier
    v_mfma_f32_16x16x32_bf16 v[44:47], a[148:151], v[160:163], v[44:47]
    ds_read_b128 v[76:79], v11 offset:0
    v_mfma_f32_16x16x32_bf16 v[48:51], a[152:155], v[160:163], v[48:51]
    ds_read_b128 v[80:83], v11 offset:1024
    v_mfma_f32_16x16x32_bf16 v[52:55], a[156:159], v[160:163], v[52:55]
    ds_read_b128 v[84:87], v11 offset:2048
    s_waitcnt vmcnt(6)
    v_mfma_f32_16x16x32_bf16 v[36:39], a[160:163], v[164:167], v[36:39]
    v_mfma_f32_16x16x32_bf16 v[40:43], a[164:167], v[164:167], v[40:43]
    ds_read_b128 v[88:91], v11 offset:3072
    v_mfma_f32_16x16x32_bf16 v[44:47], a[168:171], v[164:167], v[44:47]
    ds_read_b128 v[92:95], v11 offset:4096
    v_mfma_f32_16x16x32_bf16 v[48:51], a[172:175], v[164:167], v[48:51]
    v_fmac_f32 v226, s72, v70
    v_fmac_f32 v227, s72, v71
    v_mfma_f32_16x16x32_bf16 v[52:55], a[176:179], v[164:167], v[52:55]
    v_fmac_f32 v228, s72, v72
    v_fmac_f32 v229, s72, v73
    s_waitcnt vmcnt(5)
    v_mfma_f32_16x16x32_bf16 v[36:39], a[180:183], v[168:171], v[36:39]
    v_mfma_f32_16x16x32_bf16 v[40:43], a[184:187], v[168:171], v[40:43]
    v_fmac_f32 v230, s72, v74
    v_fmac_f32 v231, s72, v75
    v_mfma_f32_16x16x32_bf16 v[44:47], a[188:191], v[168:171], v[44:47]
    s_waitcnt lgkmcnt(0)
    v_mfma_f32_16x16x32_bf16 v[48:51], a[192:195], v[168:171], v[48:51]
    v_fmac_f32 v212, s72, v76
    v_fmac_f32 v213, s72, v77
    v_mfma_f32_16x16x32_bf16 v[52:55], a[196:199], v[168:171], v[52:55]
    v_fmac_f32 v214, s72, v78
    v_fmac_f32 v215, s72, v79
    s_waitcnt vmcnt(3)
    v_mfma_f32_16x16x32_bf16 v[36:39], a[200:203], v[172:175], v[36:39]
    v_mfma_f32_16x16x32_bf16 v[40:43], a[204:207], v[172:175], v[40:43]
    v_fmac_f32 v216, s72, v80
    v_fmac_f32 v217, s72, v81
    v_mfma_f32_16x16x32_bf16 v[44:47], a[208:211], v[172:175], v[44:47]
    v_fmac_f32 v218, s72, v82
    v_fmac_f32 v219, s72, v83
    v_mfma_f32_16x16x32_bf16 v[48:51], a[212:215], v[172:175], v[48:51]
    v_mfma_f32_16x16x32_bf16 v[52:55], a[216:219], v[172:175], v[52:55]
    s_waitcnt vmcnt(2)
    v_mfma_f32_16x16x32_bf16 v[36:39], a[220:223], v[176:179], v[36:39]
    v_mfma_f32_16x16x32_bf16 v[40:43], a[224:227], v[176:179], v[40:43]
    v_fmac_f32 v220, s72, v84
    v_fmac_f32 v221, s72, v85
    v_mfma_f32_16x16x32_bf16 v[44:47], a[228:231], v[176:179], v[44:47]
    v_fmac_f32 v222, s72, v86
    v_fmac_f32 v223, s72, v87
    v_mfma_f32_16x16x32_bf16 v[48:51], a[232:235], v[176:179], v[48:51]
    v_mfma_f32_16x16x32_bf16 v[52:55], a[236:239], v[176:179], v[52:55]
    s_waitcnt vmcnt(1)
    v_mfma_f32_16x16x32_bf16 v[36:39], a[240:243], v[180:183], v[36:39]
    v_mfma_f32_16x16x32_bf16 v[40:43], a[244:247], v[180:183], v[40:43]
    v_fmac_f32 v224, s72, v88
    v_fmac_f32 v225, s72, v89
    v_mfma_f32_16x16x32_bf16 v[44:47], a[248:251], v[180:183], v[44:47]
    v_fmac_f32 v226, s72, v90
    v_fmac_f32 v227, s72, v91
    v_mfma_f32_16x16x32_bf16 v[48:51], a[252:255], v[180:183], v[48:51]
    v_mfma_f32_16x16x32_bf16 v[52:55], v[232:235], v[180:183], v[52:55]
    s_waitcnt vmcnt(0)
    v_mfma_f32_16x16x32_bf16 v[36:39], v[236:239], v[184:187], v[36:39]
    v_mfma_f32_16x16x32_bf16 v[40:43], v[240:243], v[184:187], v[40:43]
    v_fmac_f32 v228, s72, v92
    v_fmac_f32 v229, s72, v93
    v_mfma_f32_16x16x32_bf16 v[44:47], v[244:247], v[184:187], v[44:47]
    v_fmac_f32 v230, s72, v94
    v_fmac_f32 v231, s72, v95
    v_mfma_f32_16x16x32_bf16 v[48:51], v[248:251], v[184:187], v[48:51]
    v_mfma_f32_16x16x32_bf16 v[52:55], v[252:255], v[184:187], v[52:55]
    s_add_u32 s10, s10, 1
    s_mov_b32 s31, s72
    v_pk_fma_f32 v[212:213], v[36:37], s[30:31], v[212:213] op_sel:[0,1,0] op_sel_hi:[1,1,1]
    v_pk_fma_f32 v[214:215], v[38:39], s[30:31], v[214:215] op_sel:[0,1,0] op_sel_hi:[1,1,1]
    v_pk_fma_f32 v[216:217], v[40:41], s[30:31], v[216:217] op_sel:[0,1,0] op_sel_hi:[1,1,1]
    v_pk_fma_f32 v[218:219], v[42:43], s[30:31], v[218:219] op_sel:[0,1,0] op_sel_hi:[1,1,1]
    v_pk_fma_f32 v[220:221], v[44:45], s[30:31], v[220:221] op_sel:[0,1,0] op_sel_hi:[1,1,1]
    v_pk_fma_f32 v[222:223], v[46:47], s[30:31], v[222:223] op_sel:[0,1,0] op_sel_hi:[1,1,1]
    v_pk_fma_f32 v[224:225], v[48:49], s[30:31], v[224:225] op_sel:[0,1,0] op_sel_hi:[1,1,1]
    v_pk_fma_f32 v[226:227], v[50:51], s[30:31], v[226:227] op_sel:[0,1,0] op_sel_hi:[1,1,1]
    v_pk_fma_f32 v[228:229], v[52:53], s[30:31], v[228:229] op_sel:[0,1,0] op_sel_hi:[1,1,1]
    v_pk_fma_f32 v[230:231], v[54:55], s[30:31], v[230:231] op_sel:[0,1,0] op_sel_hi:[1,1,1]
    s_cmp_eq_u32 s10, 1
    s_cbranch_scc1 L_layer
L_fin:
    v_cvt_pk_bf16_f32 v16, v212, v213
    v_cvt_pk_bf16_f32 v17, v214, v215
    ds_write_b64 v14, v[16:17] offset:0
    v_cvt_pk_bf16_f32 v18, v216, v217
    v_cvt_pk_bf16_f32 v19, v218, v219
    ds_write_b64 v14, v[18:19] offset:8
    v_cvt_pk_bf16_f32 v20, v220, v221
    v_cvt_pk_bf16_f32 v21, v222, v223
    ds_write_b64 v14, v[20:21] offset:16
    v_cvt_pk_bf16_f32 v22, v224, v225
    v_cvt_pk_bf16_f32 v23, v226, v227
    ds_write_b64 v14, v[22:23] offset:24
    v_cvt_pk_bf16_f32 v24, v228, v229
    v_cvt_pk_bf16_f32 v25, v230, v231
    ds_write_b64 v14, v[24:25] offset:32
    v_mul_u32_u24 v28, 6554, v1
    v_lshrrev_b32 v28, 16, v28
    v_mul_u32_u24 v28, 1120, v28
    v_add_u32 v28, v28, v2
    v_add_u32 v29, 64, v1
    v_mul_u32_u24 v29, 6554, v29
    v_lshrrev_b32 v29, 16, v29
    v_mul_u32_u24 v29, 1120, v29
    v_add_u32 v29, v29, v2
    v_add_u32 v30, 128, v1
    v_mul_u32_u24 v30, 6554, v30
    v_lshrrev_b32 v30, 16, v30
    v_mul_u32_u24 v30, 1120, v30
    v_add_u32 v30, v30, v2
    s_mul_i32 s96, s27, 1280
    s_mul_i32 s100, s9, 160
    s_add_u32 s96, s96, s100
    s_waitcnt lgkmcnt(0)
    ds_read_b128 v[16:19], v188
    ds_read_b128 v[20:23], v188 offset:1024
    ds_read_b128 v[24:27], v188 offset:2048
    s_waitcnt lgkmcnt(2)
    buffer_store_dwordx4 v[16:19], v28, s[36:39], s96 offen
    s_waitcnt lgkmcnt(1)
    buffer_store_dwordx4 v[20:23], v29, s[36:39], s96 offen offset:1024
    s_bfm_b64 exec, 32, 0
    s_waitcnt lgkmcnt(0)
    buffer_store_dwordx4 v[24:27], v30, s[36:39], s96 offen offset:2048
    s_mov_b64 exec, -1
L_exit:
L_end:
    s_endpgm
ool_2:
    s_waitcnt vmcnt(0)
    s_mov_b64 exec, 1
    buffer_store_dword v190, v191, s[32:35], s101 offen sc1
    s_mov_b64 exec, 1
    v_mov_b32 v56, 1
    ds_add_rtn_u32 v56, v4, v56
    s_waitcnt lgkmcnt(0)
    v_cmp_eq_u32 vcc, 3, v56
    s_cbranch_vccz arr_1
    buffer_store_dwordx2 v[114:115], v191, s[32:35], s77 offen sc1
arr_1:
    s_mov_b64 exec, -1
    s_branch back_3
pretry_6:
    s_sleep 2
    buffer_load_dword v56, v110, s[32:35], 0 offen sc1
    s_add_u32 s97, s97, 1
    s_add_u32 s97, s97, s12
    s_cmp_le_u32 s97, 40000
    s_cbranch_scc1 poll_4
    s_mov_b32 s12, 40000
    s_waitcnt vmcnt(0)
    s_branch pdone_5
ool_9:
    s_mov_b32 s96, 0
    buffer_load_dwordx2 v[100:101], v113, s[32:35], s96 offen sc1
    s_mov_b32 s96, 2048
    buffer_load_dwordx2 v[102:103], v113, s[32:35], s96 offen sc1
    s_mov_b32 s96, 4096
    buffer_load_dwordx2 v[104:105], v113, s[32:35], s96 offen sc1
    s_mov_b32 s96, 6144
    buffer_load_dwordx2 v[106:107], v113, s[32:35], s96 offen sc1
    s_branch back_10
pretry_14:
    s_sleep 2
    s_mov_b32 s96, 0
    buffer_load_dwordx2 v[100:101], v113, s[32:35], s96 offen sc1
    s_mov_b32 s96, 2048
    buffer_load_dwordx2 v[102:103], v113, s[32:35], s96 offen sc1
    s_mov_b32 s96, 4096
    buffer_load_dwordx2 v[104:105], v113, s[32:35], s96 offen sc1
    s_mov_b32 s96, 6144
    buffer_load_dwordx2 v[106:107], v113, s[32:35], s96 offen sc1
    s_add_u32 s97, s97, 1
    s_add_u32 s97, s97, s12
    s_cmp_le_u32 s97, 40000
    s_cbranch_scc1 poll_12
    s_mov_b32 s12, 40000
    s_waitcnt vmcnt(0)
    s_branch pdone_13
ool_16:
    v_mov_b32 v110, 0x154a000
    s_mov_b64 exec, 1
    buffer_store_dword v190, v110, s[32:35], 0 offen sc1
    s_mov_b64 exec, -1
    s_branch back_17
pretry_20:
    buffer_load_dwordx4 v[24:27], v2, s[32:35], s100 offen offset:0 sc1
    buffer_load_dwordx4 v[28:31], v2, s[32:35], s100 offen offset:1024 sc1
    buffer_load_dwordx4 v[32:35], v2, s[32:35], s100 offen offset:2048 sc1
    buffer_load_dwordx4 v[36:39], v2, s[32:35], s100 offen offset:3072 sc1
    buffer_load_dwordx4 v[40:43], v2, s[32:35], s101 offen offset:0 sc1
    s_add_u32 s97, s97, 1
    s_add_u32 s97, s97, s12
    s_cmp_le_u32 s97, 40000
    s_cbranch_scc1 poll_18
    s_mov_b32 s12, 40000
    s_waitcnt vmcnt(0)
    s_branch pdone_19
L_exs:
    buffer_store_dwordx4 v[44:47], v16, s[32:35], s81 offen sc1
    s_branch L_exd
ool_26:
    ds_write_b128 v188, a[176:179] offset:16384
    ds_write_b128 v188, a[180:183] offset:17408
    ds_write_b128 v188, a[184:187] offset:18432
    ds_write_b128 v188, a[188:191] offset:19456
    ds_write_b128 v188, a[192:195] offset:20480
    ds_write_b128 v188, a[196:199] offset:21504
    ds_write_b128 v188, a[200:203] offset:22528
    ds_write_b128 v188, a[204:207] offset:23552
    ds_write_b128 v188, a[208:211] offset:24576
    ds_write_b128 v188, a[212:215] offset:25600
    s_branch back_27
pretry_24:
    buffer_load_dwordx4 v[48:51], v16, s[32:35], s67 offen sc1
    buffer_load_dwordx4 v[52:55], v16, s[32:35], s68 offen sc1
    buffer_load_dwordx4 v[56:59], v16, s[32:35], s69 offen sc1
    buffer_load_dwordx4 v[60:63], v16, s[32:35], s70 offen sc1
    buffer_load_dwordx4 v[64:67], v16, s[32:35], s71 offen sc1
    buffer_load_dwordx4 v[68:71], v16, s[32:35], s44 offen sc1
    buffer_load_dwordx4 v[72:75], v16, s[32:35], s45 offen sc1
    buffer_load_dwordx4 v[76:79], v16, s[32:35], s46 offen sc1
    s_add_u32 s97, s97, 1
    s_add_u32 s97, s97, s12
    s_cmp_le_u32 s97, 40000
    s_cbranch_scc1 poll_22
    s_mov_b32 s12, 40000
    s_waitcnt vmcnt(0)
    s_branch pdone_23
ool_28:
    buffer_load_dwordx4 a[72:75], v2, s[32:35], s73 offen offset:2048 sc1
    buffer_load_dwordx4 a[76:79], v2, s[32:35], s73 offen offset:3072 sc1
    s_add_u32 s73, s73, 4096
    buffer_load_dwordx4 a[80:83], v2, s[32:35], s73 offen offset:0 sc1
    buffer_load_dwordx4 a[84:87], v2, s[32:35], s73 offen offset:1024 sc1
    buffer_load_dwordx4 a[88:91], v2, s[32:35], s73 offen offset:2048 sc1
    buffer_load_dwordx4 a[92:95], v2, s[32:35], s73 offen offset:3072 sc1
    s_branch back_29
ool_30:
    ds_write_b128 v188, a[216:219] offset:26624
    ds_write_b128 v188, a[220:223] offset:27648
    ds_write_b128 v188, a[224:227] offset:28672
    s_branch back_31
pubs_32:
    buffer_wbl2 sc1
    s_waitcnt vmcnt(0)
    buffer_store_dword v190, v191, s[32:35], s84 offen sc1
    s_branch pubb_33
ool_38:
    ds_write_b128 v188, a[228:231] offset:29696
    ds_write_b128 v188, a[232:235] offset:30720
    ds_write_b128 v188, a[236:239] offset:31744
    s_waitcnt lgkmcnt(0)
    s_barrier
    s_branch back_39
pretry_36:
    buffer_load_dword v180, v6, s[32:35], s85 offen offset:1024 sc1
    s_add_u32 s97, s97, 1
    s_add_u32 s97, s97, s12
    s_cmp_le_u32 s97, 40000
    s_cbranch_scc1 poll_34
    s_mov_b32 s12, 40000
    s_waitcnt vmcnt(0)
    s_branch pdone_35
ool_40:
    buffer_inv sc1
    s_waitcnt vmcnt(0)
    s_branch back_41
pubs_42:
    buffer_wbl2 sc1
    s_waitcnt vmcnt(0)
    buffer_store_dword v190, v191, s[32:35], s86 offen sc1
    s_branch pubb_43
pretry_46:
    buffer_load_dword v16, v7, s[32:35], s87 offen offset:2048 sc1
    s_add_u32 s97, s97, 1
    s_add_u32 s97, s97, s12
    s_cmp_le_u32 s97, 40000
    s_cbranch_scc1 poll_44
    s_mov_b32 s12, 40000
    s_waitcnt vmcnt(0)
    s_branch pdone_45
ool_48:
    buffer_inv sc1
    s_waitcnt vmcnt(0)
    s_branch back_49
L_codeend:
.section .rodata,"a"
.p2align 6
.amdhsa_kernel interleave_layers__ssm_conv_h3__dense_activation_mish__prompt_kernel
  .amdhsa_next_free_vgpr 512
  .amdhsa_next_free_sgpr 102
  .amdhsa_accum_offset 256
  .amdhsa_group_segment_fixed_size 0
  .amdhsa_kernarg_size 104
  .amdhsa_user_sgpr_count 2
  .amdhsa_user_sgpr_kernarg_segment_ptr 1
  .amdhsa_system_sgpr_workgroup_id_x 1
.end_amdhsa_kernel
```
